```python
import torch

def _softmax(x, axis=-1):
    return torch.softmax(x, dim=axis)
def _gelu(x):
    return torch.nn.functional.gelu(x, approximate="tanh")
def _silu(x):
    return torch.nn.functional.silu(x)
def _sigmoid(x):
    return torch.sigmoid(x)
def _layernorm(x, axis=-1, eps=1e-5):
    m = x.mean(dim=axis, keepdim=True)
    v = x.var(dim=axis, keepdim=True, unbiased=False)
    return (x - m) / torch.sqrt(v + eps)
def _scatter_add(tgt, idx, src, axis=0):
    return tgt.clone().index_add_(axis, idx, src)
def _segment_sum(src, seg, n):
    out = torch.zeros((n,) + src.shape[1:], dtype=src.dtype)
    return out.index_add_(0, seg, src)
def _pad(x, pw):
    flat = tuple(v for pair in reversed(pw) for v in pair)
    return torch.nn.functional.pad(x, flat)

kernel_name = 'gated_mix__ssm_conv_s5__glu_gated_glu__prompt'

def setup_inputs():

    _w = (lambda a: (lambda t: t.to(torch.bfloat16) if t.is_floating_point() else t)(torch.as_tensor(a)))
    def _A_setup():
        B, S, D = 1, 2048, 448
        P = D
        Lambda_re = -0.5 * (lambda _x: torch.exp(torch.as_tensor(_x)))((lambda *s: torch.randn(*s, dtype=torch.bfloat16) * 0.4)(P))
        Lambda_im = (lambda *s: torch.randn(*s, dtype=torch.bfloat16) * 0.8)(P) * 1.0
        B_re = (lambda *s: torch.randn(*s, dtype=torch.bfloat16) * 0.8)(P, D) * (D ** -0.5)
        B_im = (lambda *s: torch.randn(*s, dtype=torch.bfloat16) * 0.8)(P, D) * (D ** -0.5)
        C_re = (lambda *s: torch.randn(*s, dtype=torch.bfloat16) * 0.8)(D, P) * (P ** -0.5)
        C_im = (lambda *s: torch.randn(*s, dtype=torch.bfloat16) * 0.8)(D, P) * (P ** -0.5)
        log_dt = (lambda *s: torch.randn(*s, dtype=torch.bfloat16) * 0.4)(P) * 0.3 - 2.0
        Dskip = (lambda *s: torch.randn(*s, dtype=torch.bfloat16) * 0.1)(D)
        return {
            "x": _w((lambda *s: torch.randn(*s, dtype=torch.bfloat16) * 0.05)(B, S, D)),
            "Lambda_re": _w(Lambda_re),
            "Lambda_im": _w(Lambda_im),
            "B_re": _w(B_re),
            "B_im": _w(B_im),
            "C_re": _w(C_re),
            "C_im": _w(C_im),
            "log_dt": _w(log_dt),
            "Dskip": _w(Dskip),
        }
    _A_in = _A_setup()

    def _B_setup():
        B, S, D, F = 1, 2048, 448, 1792
        return {
            "x": _w((lambda *s: torch.randn(*s, dtype=torch.bfloat16) * 0.05)(B, S, D)),
            "w_gate": _w((lambda *s: torch.randn(*s, dtype=torch.bfloat16) * 0.4)(D, F)),
            "w_up": _w((lambda *s: torch.randn(*s, dtype=torch.bfloat16) * 0.05)(D, F)),
            "w_down": _w((lambda *s: torch.randn(*s, dtype=torch.bfloat16) * 0.05)(F, D)),
        }
    _B_in = _B_setup()

    return {
        "A_x": _A_in["x"],
        "A_Lambda_re": _A_in["Lambda_re"],
        "A_Lambda_im": _A_in["Lambda_im"],
        "A_B_re": _A_in["B_re"],
        "A_B_im": _A_in["B_im"],
        "A_C_re": _A_in["C_re"],
        "A_C_im": _A_in["C_im"],
        "A_log_dt": _A_in["log_dt"],
        "A_Dskip": _A_in["Dskip"],
        "B_x": _B_in["x"],
        "B_w_gate": _B_in["w_gate"],
        "B_w_up": _B_in["w_up"],
        "B_w_down": _B_in["w_down"],
        "gate_w": _w((lambda *s: torch.randn(*s, dtype=torch.bfloat16) * 0.05)(448) * 16.0),
    }

def reference(A_x, A_Lambda_re, A_Lambda_im, A_B_re, A_B_im, A_C_re, A_C_im, A_log_dt, A_Dskip, B_x, B_w_gate, B_w_up, B_w_down, gate_w):
    def _A_ref(x, Lambda_re, Lambda_im, B_re, B_im, C_re, C_im, log_dt, Dskip):
        Bsz, L, H = x.shape
        Lam = Lambda_re + 1j * Lambda_im
        Bmat = B_re + 1j * B_im
        Cmat = C_re + 1j * C_im
        dt = torch.exp(log_dt)
        Lam_bar = torch.exp(dt * Lam)
        B_bar = ((Lam_bar - 1.0) / Lam)[:, None] * Bmat
        Bu = torch.einsum("bld,pd->blp", x + 0j, B_bar)
        h = torch.zeros_like(Bu[:, 0, :])
        hs = []
        for t in range(L):
            h = Lam_bar[None, :] * h + Bu[:, t, :]
            hs.append(h)
        hseq = torch.stack(hs, 1)
        y = 2.0 * torch.einsum("blp,dp->bld", hseq, Cmat).real + x * Dskip[None, None, :]
        return y

    def _B_ref(x, w_gate, w_up, w_down):
        g = torch.einsum("bsd,df->bsf", x, w_gate)
        u = torch.einsum("bsd,df->bsf", x, w_up)
        h = _sigmoid(g) * u
        return torch.einsum("bsf,fd->bsd", h, w_down)

    x = A_x
    g = _sigmoid((x * gate_w).sum(-1, keepdims=True))
    a = _A_ref(x, A_Lambda_re, A_Lambda_im, A_B_re, A_B_im, A_C_re, A_C_im, A_log_dt, A_Dskip)
    b = _B_ref(x, B_w_gate, B_w_up, B_w_down)
    return g * a + (1 - g) * b
```

```asm
; @launch grid=(256,1,1) block=(256,1,1) lds=162048
.amdgcn_target "amdgcn-amd-amdhsa--gfx950"
.text
.globl gated_mix__ssm_conv_s5__glu_gated_glu__prompt_kernel
.p2align 8
.type gated_mix__ssm_conv_s5__glu_gated_glu__prompt_kernel,@function
gated_mix__ssm_conv_s5__glu_gated_glu__prompt_kernel:
    s_cmp_ge_u32 s2, 0x100
    s_cbranch_scc1 L_exit
    s_load_dwordx16 s[64:79], s[0:1], 0
    s_load_dwordx16 s[80:95], s[0:1], 64
    s_load_dwordx2 s[96:97], s[0:1], 128
    v_lshrrev_b32 v246, 6, v0
    v_and_b32 v245, 63, v0
    v_readfirstlane_b32 s63, v246
    s_cmp_lt_u32 s2, 32
    s_cbranch_scc1 L_spare
    s_sub_u32 s2, s2, 32
    s_and_b32 s4, s2, 7
    s_lshr_b32 s5, s2, 3
    s_mul_i32 s6, s5, 0x2493
    s_lshr_b32 s6, s6, 16
    s_mul_i32 s7, s6, 7
    s_sub_u32 s62, s5, s7
    s_and_b32 s61, s4, 1
    s_lshr_b32 s4, s4, 1
    s_lshl_b32 s59, s4, 2
    s_add_u32 s59, s59, s6
    s_mul_i32 s60, s61, 7
    s_add_u32 s60, s60, s62
    s_mul_i32 s8, s6, 0
    s_mul_i32 s7, s62, 0
    s_add_u32 s8, s8, s7
    s_mul_i32 s7, s4, 2
    s_add_u32 s8, s8, s7
    s_mul_i32 s7, s61, 3
    s_add_u32 s8, s8, s7
    s_mul_i32 s7, s8, 0x2493
    s_lshr_b32 s7, s7, 16
    s_mul_i32 s7, s7, 7
    s_sub_u32 s8, s8, s7
    s_lshl_b32 s57, s8, 7
    s_and_b32 s6, s6, 3
    s_and_b32 s7, s62, 7
    s_mul_i32 s6, s6, 2
    s_mul_i32 s7, s7, 1
    s_add_u32 s6, s6, s7
    s_mul_i32 s7, s4, 1
    s_add_u32 s6, s6, s7
    s_mul_i32 s7, s61, 0
    s_add_u32 s6, s6, s7
    s_mul_i32 s7, s6, 0x2493
    s_lshr_b32 s7, s7, 16
    s_mul_i32 s7, s7, 7
    s_sub_u32 s6, s6, s7
    s_lshl_b32 s44, s6, 7
    s_add_u32 s45, s44, 0x80
    s_cmp_eq_u32 s45, 0x380
    s_cselect_b32 s45, 0, s45
    s_add_u32 s46, s45, 0x80
    s_cmp_eq_u32 s46, 0x380
    s_cselect_b32 s46, 0, s46
    s_add_u32 s47, s46, 0x80
    s_cmp_eq_u32 s47, 0x380
    s_cselect_b32 s47, 0, s47
    s_add_u32 s48, s47, 0x80
    s_cmp_eq_u32 s48, 0x380
    s_cselect_b32 s48, 0, s48
    s_add_u32 s49, s48, 0x80
    s_cmp_eq_u32 s49, 0x380
    s_cselect_b32 s49, 0, s49
    s_add_u32 s50, s49, 0x80
    s_cmp_eq_u32 s50, 0x380
    s_cselect_b32 s50, 0, s50
    s_lshl_b32 s3, s63, 12
    s_lshl_b32 s58, s63, 11
    s_and_b32 s98, s63, 1
    s_lshr_b32 s99, s63, 1
    s_mul_i32 s100, s59, 0x1c000
    s_mul_i32 s101, s60, 0x7000
    v_lshrrev_b32 v246, 3, v245
    v_and_b32 v247, 7, v245
    v_lshrrev_b32 v248, 4, v245
    v_xor_b32 v248, v248, v247
    v_lshlrev_b32 v248, 4, v248
    v_xor_b32 v249, 64, v248
    v_and_b32 v250, 3, v246
    v_lshrrev_b32 v251, 2, v246
    v_lshl_add_u32 v250, v251, 4, v250
    s_lshl_b32 s7, s63, 5
    v_add_u32 v250, s7, v250
    v_mul_u32_u24 v250, 0x380, v250
    v_add_u32 v192, v250, v248
    v_add_u32 v251, v250, v249
    v_add_u32 v193, 0xa00, v251
    v_add_u32 v194, 0x1400, v192
    v_add_u32 v195, 0x1e00, v251
    s_lshl_b32 s7, s63, 4
    v_add_u32 v250, s7, v246
    v_mul_u32_u24 v250, 0x380, v250
    v_add_u32 v200, v250, v248
    v_add_u32 v250, v250, v249
    v_add_u32 v201, 0x1800, v250
    v_mov_b32 v255, 0x7ff00000
    v_and_b32 v252, 31, v245
    s_lshl_b32 s7, s60, 5
    v_add_u32 v253, s7, v252
    v_lshlrev_b32 v253, 1, v253
    s_waitcnt lgkmcnt(0)
    s_add_u32 s4, s64, s100
    s_addc_u32 s5, s65, 0
    s_mov_b32 s6, 0x1c000
    s_mov_b32 s7, 0x20000
    s_add_u32 m0, s3, 0
    s_nop 0
    buffer_load_dwordx4 v192, s[4:7], s44 offen lds
    buffer_load_dwordx4 v193, s[4:7], s44 offen offset:1024 lds
    buffer_load_dwordx4 v194, s[4:7], s44 offen offset:2048 lds
    buffer_load_dwordx4 v195, s[4:7], s44 offen offset:3072 lds
    s_cmp_ge_u32 s63, 2
    s_cselect_b32 s0, s72, s70
    s_cselect_b32 s1, s73, s71
    s_cselect_b32 s10, 0x7000, 0
    s_sub_u32 s0, s0, s10
    s_subb_u32 s1, s1, 0
    s_add_u32 s8, s0, s101
    s_addc_u32 s9, s1, 0
    s_add_u32 s10, s10, 0x7000
    s_mov_b32 s11, 0x20000
    s_add_u32 m0, s58, 0x4000
    s_nop 0
    buffer_load_dwordx4 v200, s[8:11], s44 offen lds
    buffer_load_dwordx4 v201, s[8:11], s44 offen offset:1024 lds
    s_mov_b32 s42, 0x380
    s_mov_b32 s43, 0x20000
    s_mov_b32 s40, s66
    s_mov_b32 s41, s67
    buffer_load_ushort v222, v253, s[40:43], 0 offen
    s_mov_b32 s40, s68
    s_mov_b32 s41, s69
    buffer_load_ushort v223, v253, s[40:43], 0 offen
    s_mov_b32 s40, s78
    s_mov_b32 s41, s79
    buffer_load_ushort v224, v253, s[40:43], 0 offen
    s_lshl_b32 s0, s62, 1
    s_add_u32 s0, s0, s98
    s_lshl_b32 s0, s0, 6
    v_lshl_add_u32 v250, v252, 1, s0
    s_mov_b32 s40, s80
    s_mov_b32 s41, s81
    buffer_load_ushort a242, v250, s[40:43], 0 offen
    s_mov_b32 s24, s96
    s_mov_b32 s25, s97
    s_mov_b32 s26, 0x10000000
    s_mov_b32 s27, 0x20000
    s_lshl_b32 s0, s59, 4
    s_add_u32 s0, s0, s63
    s_lshl_b32 s0, s0, 7
    s_lshl_b32 s1, s60, 2
    s_add_u32 s0, s0, s1
    s_add_u32 s0, s0, 0xb0e000
    v_mov_b32 v250, s0
    v_cmp_eq_u32 vcc, 0, v245
    s_lshl_b32 s0, s60, 12
    s_add_u32 s0, s0, 0xb00000
    v_cndmask_b32 v240, v255, v250, vcc
    s_add_u32 s28, s96, s0
    s_addc_u32 s29, s97, 0
    s_mov_b32 s30, 0x1000
    s_mov_b32 s31, 0x20000
    s_sub_u32 s0, 15, s59
    s_lshl_b32 s0, s0, 8
    v_lshlrev_b32 v250, 3, v252
    v_add_u32 v250, s0, v250
    v_cmp_lt_u32 vcc, 0xdf, v0
    s_add_u32 s0, s0, 0x100
    v_lshlrev_b32 v251, 4, v0
    v_cndmask_b32 v238, v255, v250, vcc
    v_add_u32 v239, s0, v251
    s_lshl_b32 s0, s61, 6
    s_mul_i32 s1, s98, 24
    s_sub_u32 s0, s0, s1
    s_lshl_b32 s1, s99, 5
    s_sub_u32 s0, s0, s1
    s_mul_i32 s0, s0, 0x380
    s_lshl_b32 s1, s62, 7
    s_add_u32 s0, s0, s1
    v_add_u32 v250, s0, v192
    v_add_u32 v251, s0, v193
    v_accvgpr_write_b32 a240, v250
    v_accvgpr_write_b32 a241, v251
    s_cmp_ge_u32 s63, 2
    s_cselect_b32 s12, s86, s84
    s_cselect_b32 s13, s87, s85
    s_lshl_b32 s0, s60, 8
    s_sub_u32 s1, 0x188000, s0
    s_add_u32 s12, s12, s0
    s_addc_u32 s13, s13, 0
    s_mov_b32 s14, s1
    s_mov_b32 s15, 0x20000
    s_lshl_b32 s0, s62, 7
    s_sub_u32 s1, 0x188000, s0
    s_add_u32 s16, s88, s0
    s_addc_u32 s17, s89, 0
    s_mov_b32 s18, s1
    s_mov_b32 s19, 0x20000
    s_cmp_eq_u32 s61, 1
    s_cselect_b32 s20, s76, s74
    s_cselect_b32 s21, s77, s75
    s_mul_i32 s0, s62, 0xe000
    s_add_u32 s20, s20, s0
    s_addc_u32 s21, s21, 0
    s_mov_b32 s22, 0xe000
    s_mov_b32 s23, 0x20000
    s_cmp_ge_u32 s63, 2
    s_cselect_b32 s20, s16, s20
    s_cselect_b32 s21, s17, s21
    s_cselect_b32 s22, s18, s22
    s_mov_b32 s32, s92
    s_mov_b32 s33, s93
    s_mov_b32 s34, 0x380000
    s_mov_b32 s35, 0x20000
    s_mov_b32 s36, s94
    s_mov_b32 s37, s95
    s_mov_b32 s38, 0x100
    s_mov_b32 s39, 0x20000
    s_mov_b32 s90, s57
    s_mul_i32 s51, s44, 0x700
    s_mul_i32 s52, s45, 0x700
    s_mul_i32 s53, s46, 0x700
    s_mul_i32 s54, s47, 0x700
    s_mul_i32 s55, s48, 0x700
    s_mul_i32 s56, s49, 0x700
    s_mul_i32 s57, s50, 0x700
    s_add_u32 s91, s90, 0x80
    s_cmp_eq_u32 s91, 0x380
    s_cselect_b32 s91, 0, s91
    s_add_u32 s92, s91, 0x80
    s_cmp_eq_u32 s92, 0x380
    s_cselect_b32 s92, 0, s92
    s_add_u32 s93, s92, 0x80
    s_cmp_eq_u32 s93, 0x380
    s_cselect_b32 s93, 0, s93
    s_add_u32 s94, s93, 0x80
    s_cmp_eq_u32 s94, 0x380
    s_cselect_b32 s94, 0, s94
    s_add_u32 s95, s94, 0x80
    s_cmp_eq_u32 s95, 0x380
    s_cselect_b32 s95, 0, s95
    s_add_u32 s96, s95, 0x80
    s_cmp_eq_u32 s96, 0x380
    s_cselect_b32 s96, 0, s96
    s_lshl_b32 s64, s90, 5
    s_lshl_b32 s65, s91, 5
    s_lshl_b32 s66, s92, 5
    s_lshl_b32 s67, s93, 5
    s_lshl_b32 s68, s94, 5
    s_lshl_b32 s69, s95, 5
    s_lshl_b32 s70, s96, 5
    s_cmp_ge_u32 s63, 2
    s_cselect_b32 s97, 0x700, 1
    s_cselect_b64 s[82:83], -1, 0
    s_lshl_b32 s0, s98, 5
    v_add_u32 v250, s0, v246
    v_mul_u32_u24 v250, 0x380, v250
    v_bfe_u32 v251, v245, 4, 1
    v_lshlrev_b32 v251, 2, v251
    v_xor_b32 v251, v251, v247
    v_lshlrev_b32 v251, 4, v251
    v_lshl_add_u32 v196, v250, 2, v251
    v_add_u32 v197, 0x6c00, v196
    v_add_u32 v198, 0xd800, v196
    v_add_u32 v199, 0x14400, v196
    s_mul_i32 s0, s99, 0x1c000
    s_add_u32 s0, s0, 0xe000
    v_add3_u32 v253, v250, v251, s0
    v_accvgpr_write_b32 a236, v253
    v_add_u32 v253, 0x1800, v253
    v_accvgpr_write_b32 a237, v253
    v_add_u32 v253, 0x1800, v253
    v_accvgpr_write_b32 a238, v253
    v_add_u32 v253, 0x1800, v253
    v_accvgpr_write_b32 a239, v253
    s_mul_i32 s0, s98, 0x15000
    s_mul_i32 s1, s61, 0x7000
    s_add_u32 s0, s0, s1
    v_add3_u32 v251, v250, v251, s0
    v_add_u32 v248, v250, v248
    v_add_u32 v249, v250, v249
    v_cndmask_b32 v248, v248, v251, s[82:83]
    v_cndmask_b32 v249, v249, v251, s[82:83]
    v_accvgpr_write_b32 a232, v248
    v_add_u32 v249, 0x1800, v249
    v_add_u32 v248, 0x3000, v248
    v_accvgpr_write_b32 a233, v249
    v_accvgpr_write_b32 a234, v248
    v_add_u32 v249, 0x3000, v249
    v_accvgpr_write_b32 a235, v249
    v_lshrrev_b32 v248, 5, v245
    v_bfe_u32 v249, v252, 1, 3
    v_xor_b32 v249, v249, v248
    v_lshlrev_b32 v249, 4, v249
    v_lshl_add_u32 v249, v252, 7, v249
    v_xor_b32 v208, 0, v249
    v_xor_b32 v209, 32, v249
    v_xor_b32 v210, 64, v249
    v_xor_b32 v211, 0x60, v249
    v_add_u32 v212, s3, v208
    v_add_u32 v213, s3, v209
    v_add_u32 v214, s3, v210
    v_add_u32 v215, s3, v211
    s_xor_b32 s0, s3, 0x1000
    v_add_u32 v4, s0, v208
    v_add_u32 v5, s0, v209
    v_add_u32 v6, s0, v210
    v_add_u32 v7, s0, v211
    v_bfe_u32 v250, v245, 2, 2
    v_lshl_add_u32 v251, v248, 3, v250
    v_lshlrev_b32 v246, 7, v251
    v_bfe_u32 v247, v245, 3, 1
    v_xor_b32 v247, s98, v247
    v_lshl_add_u32 v246, v247, 6, v246
    v_bfe_u32 v247, v245, 4, 1
    v_lshlrev_b32 v247, 5, v247
    v_and_b32 v253, 3, v245
    v_lshl_add_u32 v247, v253, 3, v247
    v_add_u32 v216, v246, v247
    s_mul_i32 s0, s63, 0x900
    s_add_u32 s0, s0, 0x24000
    v_mul_u32_u24 v251, 0x48, v251
    v_add3_u32 v244, v251, v247, s0
    v_mul_u32_u24 v251, 0x48, v252
    v_lshl_add_u32 v251, v248, 3, v251
    v_add_u32 v243, s0, v251
    v_lshrrev_b32 v251, 5, v0
    v_lshlrev_b32 v251, 8, v251
    v_lshl_add_u32 v251, v252, 3, v251
    v_add_u32 v237, 0x26400, v251
    v_lshlrev_b32 v251, 3, v0
    v_add_u32 v251, 0x26400, v251
    v_mov_b32 v246, 0
    v_mov_b32 v247, 0
    ds_write_b64 v251, v[246:247]
    v_lshlrev_b32 v251, 4, v245
    s_mul_i32 s0, s59, 0xa8000
    s_mul_i32 s1, s98, 0x7000
    s_add_u32 s76, s1, 0x70000
    s_add_u32 s0, s0, s1
    s_mul_i32 s1, s99, 0xe000
    s_add_u32 s0, s0, s1
    s_mul_i32 s100, s61, 0xfffeb000
    s_add_u32 s100, s100, s0
    s_mul_i32 s80, s98, 0x6800
    s_sub_u32 s100, s100, s80
    s_add_u32 s100, s100, 0x8c000
    v_add_u32 v219, s100, v251
    s_mul_i32 s79, s61, 0x38000
    s_sub_u32 s79, s79, 0x1c000
    s_mul_i32 s100, s61, 0x7000
    s_sub_u32 s80, s80, s100
    s_add_u32 s80, s80, 0x38000
    s_add_u32 s0, s0, s1
    s_lshl_b32 s1, s60, 11
    s_add_u32 s0, s0, s1
    v_add_u32 v218, s0, v251
    s_mul_i32 s74, s98, 0xe000
    s_sub_u32 s75, 0xe000, s74
    v_and_b32 v250, 15, v245
    v_cmp_gt_u32 vcc, 14, v250
    s_lshl_b32 s0, s59, 11
    s_add_u32 s0, s0, 0xb0e000
    s_xor_b32 s1, s61, 1
    v_cndmask_b32 v251, 0, v250, vcc
    v_lshl_add_u32 v251, v251, 2, s0
    v_bfe_u32 v250, v245, 4, 1
    v_xor_b32 v250, s1, v250
    v_lshl_add_u32 v241, v250, 8, v251
    s_lshl_b32 s0, s61, 1
    s_add_u32 s0, s0, s98
    s_lshl_b32 s0, s0, 7
    v_add_u32 v242, s0, v251
    v_and_b32 v206, 31, v245
    v_lshlrev_b32 v206, 2, v206
    v_mov_b32 v204, 1
    s_add_u32 m0, s3, 0x8000
    s_nop 0
    buffer_load_dwordx4 v192, s[4:7], s45 offen lds
    buffer_load_dwordx4 v193, s[4:7], s45 offen offset:1024 lds
    buffer_load_dwordx4 v194, s[4:7], s45 offen offset:2048 lds
    buffer_load_dwordx4 v195, s[4:7], s45 offen offset:3072 lds
    s_add_u32 m0, s58, 0x6000
    s_nop 0
    buffer_load_dwordx4 v200, s[8:11], s45 offen lds
    buffer_load_dwordx4 v201, s[8:11], s45 offen offset:1024 lds
    s_waitcnt vmcnt(10) lgkmcnt(0)
    s_barrier
    ds_read_b128 a[0:3], v212
    ds_read_b128 v[160:163], v208 offset:16384
    ds_read_b128 v[164:167], v208 offset:20480
    ds_read_b128 a[4:7], v4
    s_add_u32 m0, s3, 0xc000
    s_nop 0
    buffer_load_dwordx4 v192, s[4:7], s46 offen lds
    s_waitcnt lgkmcnt(1)
    v_mfma_f32_32x32x16_bf16 v[128:143], a[0:3], v[160:163], 0
    ds_read_b128 a[8:11], v213
    ds_read_b128 v[168:171], v209 offset:16384
    ds_read_b128 v[172:175], v209 offset:20480
    ds_read_b128 a[12:15], v5
    buffer_load_dwordx4 v193, s[4:7], s46 offen offset:1024 lds
    v_mfma_f32_32x32x16_bf16 v[144:159], a[0:3], v[164:167], 0
    ds_read_b128 a[16:19], v214
    ds_read_b128 v[176:179], v210 offset:16384
    buffer_load_dwordx4 v194, s[4:7], s46 offen offset:2048 lds
    s_waitcnt lgkmcnt(3)
    v_mfma_f32_32x32x16_bf16 v[128:143], a[8:11], v[168:171], v[128:143]
    ds_read_b128 v[180:183], v210 offset:20480
    ds_read_b128 a[20:23], v6
    buffer_load_dwordx4 v195, s[4:7], s46 offen offset:3072 lds
    s_add_u32 m0, s58, 0x10000
    v_mfma_f32_32x32x16_bf16 v[144:159], a[8:11], v[172:175], v[144:159]
    ds_read_b128 a[24:27], v215
    ds_read_b128 v[184:187], v211 offset:16384
    buffer_load_dwordx4 v200, s[8:11], s46 offen lds
    s_waitcnt vmcnt(12)
    v_lshlrev_b32 v224, 16, v224
    v_lshlrev_b32 v254, 16, v222
    v_mul_f32 v224, 0x3fb8aa3b, v224
    v_lshlrev_b32 v255, 16, v223
    v_exp_f32 v224, v224
    v_mul_f32 v248, v254, v254
    s_waitcnt lgkmcnt(3)
    v_mfma_f32_32x32x16_bf16 v[128:143], a[16:19], v[176:179], v[128:143]
    ds_read_b128 v[188:191], v211 offset:20480
    ds_read_b128 a[28:31], v7
    buffer_load_dwordx4 v201, s[8:11], s46 offen offset:1024 lds
    s_add_u32 m0, s3, 0x14000
    v_cvt_pk_bf16_f32 v224, v224, v224
    v_fma_f32 v248, v255, v255, v248
    v_lshlrev_b32 v224, 16, v224
    v_rcp_f32 v231, v248
    v_mul_f32 v246, v224, v254
    v_mul_f32 v247, v224, v255
    v_mfma_f32_32x32x16_bf16 v[144:159], a[16:19], v[180:183], v[144:159]
    s_waitcnt vmcnt(6)
    s_barrier
    ds_read_b128 a[32:35], v212 offset:32768
    ds_read_b128 v[160:163], v208 offset:24576
    buffer_load_dwordx4 v192, s[4:7], s47 offen lds
    v_mul_f32 v246, 0x3fb8aa3b, v246
    v_mul_f32 v247, 0x3e22f983, v247
    v_fract_f32 v251, v247
    v_exp_f32 v250, v246
    s_waitcnt lgkmcnt(3)
    v_mfma_f32_32x32x16_bf16 v[128:143], a[24:27], v[184:187], v[128:143]
    ds_read_b128 v[164:167], v208 offset:28672
    ds_read_b128 a[36:39], v4 offset:32768
    buffer_load_dwordx4 v193, s[4:7], s47 offen offset:1024 lds
    v_cos_f32 v252, v251
    v_sin_f32 v253, v251
    v_mul_f32 v220, v250, v252
    v_mul_f32 v221, v250, v253
    v_add_f32 v249, -1.0, v220
    v_add_f32 v248, v231, v231
    v_mfma_f32_32x32x16_bf16 v[144:159], a[24:27], v[188:191], v[144:159]
    ds_read_b128 a[40:43], v213 offset:32768
    ds_read_b128 v[168:171], v209 offset:24576
    buffer_load_dwordx4 v194, s[4:7], s47 offen offset:2048 lds
    v_mul_f32 v250, v249, v254
    v_mul_f32 v251, v221, v254
    v_fma_f32 v250, v221, v255, v250
    v_fma_f32 v251, -v249, v255, v251
    v_mul_f32 v230, v250, v248
    v_mul_f32 v231, v251, v248
    v_mul_f32 v249, 0x41800000, v247
    s_waitcnt lgkmcnt(3)
    v_mfma_f32_32x32x16_bf16 v[128:143], a[32:35], v[160:163], v[128:143]
    ds_read_b128 v[172:175], v209 offset:28672
    ds_read_b128 a[44:47], v5 offset:32768
    buffer_load_dwordx4 v195, s[4:7], s47 offen offset:3072 lds
    s_add_u32 m0, s58, 0x12000
    v_mul_f32 v248, 0x41800000, v246
    v_fract_f32 v251, v249
    v_exp_f32 v250, v248
    v_cos_f32 v252, v251
    v_mfma_f32_32x32x16_bf16 v[144:159], a[32:35], v[164:167], v[144:159]
    ds_read_b128 a[48:51], v214 offset:32768
    ds_read_b128 v[176:179], v210 offset:24576
    buffer_load_dwordx4 v200, s[8:11], s47 offen lds
    v_sin_f32 v253, v251
    v_mul_f32 v222, v250, v252
    v_mul_f32 v223, v250, v253
    v_mul_f32 v249, 0x43000000, v247
    v_mul_f32 v248, 0x43000000, v246
    v_fract_f32 v251, v249
    s_waitcnt lgkmcnt(3)
    v_mfma_f32_32x32x16_bf16 v[128:143], a[40:43], v[168:171], v[128:143]
    ds_read_b128 v[180:183], v210 offset:28672
    ds_read_b128 a[52:55], v6 offset:32768
    buffer_load_dwordx4 v201, s[8:11], s47 offen offset:1024 lds
    s_add_u32 m0, s3, 0x18000
    v_exp_f32 v250, v248
    v_cos_f32 v252, v251
    v_sin_f32 v253, v251
    v_mul_f32 v224, v250, v252
    v_mfma_f32_32x32x16_bf16 v[144:159], a[40:43], v[172:175], v[144:159]
    ds_read_b128 a[56:59], v215 offset:32768
    ds_read_b128 v[184:187], v211 offset:24576
    buffer_load_dwordx4 v192, s[4:7], s48 offen lds
    v_mul_f32 v225, v250, v253
    v_mul_f32 v249, 0x44800000, v247
    v_mul_f32 v248, 0x44800000, v246
    v_fract_f32 v251, v249
    v_exp_f32 v250, v248
    s_waitcnt lgkmcnt(3)
    v_mfma_f32_32x32x16_bf16 v[128:143], a[48:51], v[176:179], v[128:143]
    ds_read_b128 v[188:191], v211 offset:28672
    ds_read_b128 a[60:63], v7 offset:32768
    buffer_load_dwordx4 v193, s[4:7], s48 offen offset:1024 lds
    v_cos_f32 v252, v251
    v_sin_f32 v253, v251
    v_mul_f32 v226, v250, v252
    v_mul_f32 v227, v250, v253
    v_lshrrev_b32 v254, 5, v245
    s_lshl_b32 s100, s63, 1
    v_mfma_f32_32x32x16_bf16 v[144:159], a[48:51], v[180:183], v[144:159]
    s_waitcnt vmcnt(8)
    s_barrier
    ds_read_b128 a[64:67], v212 offset:49152
    v_add_u32 v208, 0x10000, v208
    ds_read_b128 v[160:163], v208
    buffer_load_dwordx4 v194, s[4:7], s48 offen offset:2048 lds
    v_add_u32 v254, s100, v254
    v_lshlrev_b32 v254, 4, v254
    v_cvt_f32_u32 v254, v254
    v_mul_f32 v249, v254, v247
    s_waitcnt lgkmcnt(3)
    v_mfma_f32_32x32x16_bf16 v[128:143], a[56:59], v[184:187], v[128:143]
    ds_read_b128 v[164:167], v208 offset:4096
    ds_read_b128 a[68:71], v4 offset:49152
    buffer_load_dwordx4 v195, s[4:7], s48 offen offset:3072 lds
    s_add_u32 m0, s58, 0x1c000
    v_mul_f32 v248, v254, v246
    v_fract_f32 v251, v249
    v_exp_f32 v250, v248
    v_cos_f32 v252, v251
    v_mfma_f32_32x32x16_bf16 v[144:159], a[56:59], v[188:191], v[144:159]
    ds_read_b128 a[72:75], v213 offset:49152
    v_add_u32 v209, 0x10000, v209
    ds_read_b128 v[168:171], v209
    buffer_load_dwordx4 v200, s[8:11], s48 offen lds
    v_sin_f32 v253, v251
    v_mul_f32 v228, v250, v252
    v_mul_f32 v229, v250, v253
    v_sub_f32 v253, 0, v221
    v_sub_f32 v252, 0, v230
    s_waitcnt lgkmcnt(3)
    v_mfma_f32_32x32x16_bf16 v[128:143], a[64:67], v[160:163], v[128:143]
    ds_read_b128 v[172:175], v209 offset:4096
    ds_read_b128 a[76:79], v5 offset:49152
    buffer_load_dwordx4 v201, s[8:11], s48 offen offset:1024 lds
    s_add_u32 m0, s3, 0x20000
    v_sub_f32 v231, 0, v231
    s_mov_b32 s1, 0xbfb8aa3b
    v_mfma_f32_32x32x16_bf16 v[144:159], a[64:67], v[164:167], v[144:159]
    ds_read_b128 a[80:83], v214 offset:49152
    v_add_u32 v210, 0x10000, v210
    ds_read_b128 v[176:179], v210
    buffer_load_dwordx4 v196, s[12:15], s51 offen lds
    s_waitcnt lgkmcnt(3)
    v_mfma_f32_32x32x16_bf16 v[128:143], a[72:75], v[168:171], v[128:143]
    ds_read_b128 v[180:183], v210 offset:4096
    ds_read_b128 a[84:87], v6 offset:49152
    buffer_load_dwordx4 v197, s[12:15], s51 offen offset:1024 lds
    v_mfma_f32_32x32x16_bf16 v[144:159], a[72:75], v[172:175], v[144:159]
    ds_read_b128 a[88:91], v215 offset:49152
    v_add_u32 v211, 0x10000, v211
    ds_read_b128 v[184:187], v211
    buffer_load_dwordx4 v198, s[12:15], s51 offen offset:2048 lds
    s_waitcnt lgkmcnt(3)
    v_mfma_f32_32x32x16_bf16 v[128:143], a[80:83], v[176:179], v[128:143]
    ds_read_b128 v[188:191], v211 offset:4096
    ds_read_b128 a[92:95], v7 offset:49152
    buffer_load_dwordx4 v199, s[12:15], s51 offen offset:3072 lds
    s_add_u32 m0, s3, 0
    v_mfma_f32_32x32x16_bf16 v[144:159], a[80:83], v[180:183], v[144:159]
    s_waitcnt vmcnt(10)
    s_barrier
    v_add_u32 v212, 0x14000, v212
    ds_read_b128 a[96:99], v212
    ds_read_b128 v[160:163], v208 offset:8192
    buffer_load_dwordx4 v192, s[4:7], s49 offen lds
    s_waitcnt lgkmcnt(3)
    v_mfma_f32_32x32x16_bf16 v[128:143], a[88:91], v[184:187], v[128:143]
    ds_read_b128 v[164:167], v208 offset:12288
    v_add_u32 v4, 0x14000, v4
    ds_read_b128 a[100:103], v4
    buffer_load_dwordx4 v193, s[4:7], s49 offen offset:1024 lds
    v_mfma_f32_32x32x16_bf16 v[144:159], a[88:91], v[188:191], v[144:159]
    v_add_u32 v213, 0x14000, v213
    ds_read_b128 a[104:107], v213
    ds_read_b128 v[168:171], v209 offset:8192
    buffer_load_dwordx4 v194, s[4:7], s49 offen offset:2048 lds
    s_waitcnt lgkmcnt(3)
    v_mfma_f32_32x32x16_bf16 v[128:143], a[96:99], v[160:163], v[128:143]
    ds_read_b128 v[172:175], v209 offset:12288
    v_add_u32 v5, 0x14000, v5
    ds_read_b128 a[108:111], v5
    buffer_load_dwordx4 v195, s[4:7], s49 offen offset:3072 lds
    s_add_u32 m0, s58, 0x1e000
    v_mfma_f32_32x32x16_bf16 v[144:159], a[96:99], v[164:167], v[144:159]
    v_add_u32 v214, 0x14000, v214
    ds_read_b128 a[112:115], v214
    ds_read_b128 v[176:179], v210 offset:8192
    buffer_load_dwordx4 v200, s[8:11], s49 offen lds
    s_waitcnt lgkmcnt(3)
    v_mfma_f32_32x32x16_bf16 v[128:143], a[104:107], v[168:171], v[128:143]
    ds_read_b128 v[180:183], v210 offset:12288
    v_add_u32 v6, 0x14000, v6
    ds_read_b128 a[116:119], v6
    buffer_load_dwordx4 v201, s[8:11], s49 offen offset:1024 lds
    s_add_u32 m0, s3, 0x4000
    v_mfma_f32_32x32x16_bf16 v[144:159], a[104:107], v[172:175], v[144:159]
    v_add_u32 v215, 0x14000, v215
    ds_read_b128 a[120:123], v215
    ds_read_b128 v[184:187], v211 offset:8192
    buffer_load_dwordx4 v192, s[4:7], s50 offen lds
    s_waitcnt lgkmcnt(3)
    v_mfma_f32_32x32x16_bf16 v[128:143], a[112:115], v[176:179], v[128:143]
    ds_read_b128 v[188:191], v211 offset:12288
    v_add_u32 v7, 0x14000, v7
    ds_read_b128 a[124:127], v7
    buffer_load_dwordx4 v193, s[4:7], s50 offen offset:1024 lds
    v_mfma_f32_32x32x16_bf16 v[144:159], a[112:115], v[180:183], v[144:159]
    s_waitcnt vmcnt(8)
    s_barrier
    ds_read_b128 a[128:131], v212 offset:16384
    ds_read_b128 v[160:163], v208 offset:49152
    buffer_load_dwordx4 v194, s[4:7], s50 offen offset:2048 lds
    s_waitcnt lgkmcnt(3)
    v_mfma_f32_32x32x16_bf16 v[128:143], a[120:123], v[184:187], v[128:143]
    ds_read_b128 v[164:167], v208 offset:53248
    ds_read_b128 a[132:135], v4 offset:16384
    buffer_load_dwordx4 v195, s[4:7], s50 offen offset:3072 lds
    s_add_u32 m0, s58, 0x8000
    v_mfma_f32_32x32x16_bf16 v[144:159], a[120:123], v[188:191], v[144:159]
    v_add_u32 v216, 0x14000, v216
    ds_read_b64_tr_b16 v[168:169], v216 offset:49152
    ds_read_b64_tr_b16 v[170:171], v216 offset:49664
    buffer_load_dwordx4 v200, s[8:11], s50 offen lds
    s_waitcnt lgkmcnt(3)
    v_mfma_f32_32x32x16_bf16 v[128:143], a[128:131], v[160:163], v[128:143]
    ds_read_b64_tr_b16 v[172:173], v216 offset:57344
    ds_read_b64_tr_b16 v[174:175], v216 offset:57856
    buffer_load_dwordx4 v201, s[8:11], s50 offen offset:1024 lds
    s_add_u32 m0, s3, 0xc000
    v_mfma_f32_32x32x16_bf16 v[144:159], a[128:131], v[164:167], v[144:159]
    ds_read_b128 a[136:139], v213 offset:16384
    ds_read_b128 v[176:179], v209 offset:49152
    buffer_load_dwordx4 v196, s[12:15], s52 offen lds
    s_waitcnt lgkmcnt(2)
    v_mfma_f32_32x32x16_bf16 v[64:79], v[168:171], a[0:3], 0
    ds_read_b128 v[180:183], v209 offset:53248
    ds_read_b128 a[140:143], v5 offset:16384
    v_mfma_f32_32x32x16_bf16 v[96:111], v[172:175], a[0:3], 0
    ds_read_b64_tr_b16 v[184:185], v216 offset:51200
    ds_read_b64_tr_b16 v[186:187], v216 offset:51712
    buffer_load_dwordx4 v197, s[12:15], s52 offen offset:1024 lds
    v_mfma_f32_32x32x16_bf16 v[80:95], v[168:171], a[4:7], 0
    ds_read_b64_tr_b16 v[188:189], v216 offset:59392
    ds_read_b64_tr_b16 v[190:191], v216 offset:59904
    v_mfma_f32_32x32x16_bf16 v[112:127], v[172:175], a[4:7], 0
    ds_read_b128 a[144:147], v214 offset:16384
    ds_read_b128 v[160:163], v210 offset:49152
    buffer_load_dwordx4 v198, s[12:15], s52 offen offset:2048 lds
    s_waitcnt lgkmcnt(7)
    v_mfma_f32_32x32x16_bf16 v[128:143], a[136:139], v[176:179], v[128:143]
    ds_read_b128 v[164:167], v210 offset:53248
    ds_read_b128 a[148:151], v6 offset:16384
    buffer_load_dwordx4 v199, s[12:15], s52 offen offset:3072 lds
    s_add_u32 m0, s3, 0x10000
    v_mfma_f32_32x32x16_bf16 v[144:159], a[136:139], v[180:183], v[144:159]
    ds_read_b64_tr_b16 v[168:169], v216 offset:53248
    ds_read_b64_tr_b16 v[170:171], v216 offset:53760
    s_waitcnt lgkmcnt(6)
    v_mfma_f32_32x32x16_bf16 v[64:79], v[184:187], a[8:11], v[64:79]
    ds_read_b64_tr_b16 v[172:173], v216 offset:61440
    ds_read_b64_tr_b16 v[174:175], v216 offset:61952
    v_mfma_f32_32x32x16_bf16 v[96:111], v[188:191], a[8:11], v[96:111]
    v_mfma_f32_32x32x16_bf16 v[80:95], v[184:187], a[12:15], v[80:95]
    v_mfma_f32_32x32x16_bf16 v[112:127], v[188:191], a[12:15], v[112:127]
    ds_read_b128 a[152:155], v215 offset:16384
    ds_read_b128 v[176:179], v211 offset:49152
    s_waitcnt lgkmcnt(7)
    v_mfma_f32_32x32x16_bf16 v[128:143], a[144:147], v[160:163], v[128:143]
    ds_read_b128 v[180:183], v211 offset:53248
    ds_read_b128 a[156:159], v7 offset:16384
    v_mfma_f32_32x32x16_bf16 v[144:159], a[144:147], v[164:167], v[144:159]
    ds_read_b64_tr_b16 v[184:185], v216 offset:55296
    ds_read_b64_tr_b16 v[186:187], v216 offset:55808
    s_waitcnt lgkmcnt(6)
    v_mfma_f32_32x32x16_bf16 v[64:79], v[168:171], a[16:19], v[64:79]
    ds_read_b64_tr_b16 v[188:189], v216 offset:63488
    ds_read_b64_tr_b16 v[190:191], v216 offset:64000
    v_mfma_f32_32x32x16_bf16 v[96:111], v[172:175], a[16:19], v[96:111]
    v_mfma_f32_32x32x16_bf16 v[80:95], v[168:171], a[20:23], v[80:95]
    v_mfma_f32_32x32x16_bf16 v[112:127], v[172:175], a[20:23], v[112:127]
    s_waitcnt vmcnt(10)
    s_barrier
    v_add_u32 v212, 0xfffec000, v212
    ds_read_b128 a[160:163], v212
    ds_read_b128 v[160:163], v208 offset:57344
    buffer_load_dwordx4 v196, s[12:15], s53 offen lds
    s_waitcnt lgkmcnt(7)
    v_mfma_f32_32x32x16_bf16 v[128:143], a[152:155], v[176:179], v[128:143]
    ds_read_b128 v[164:167], v208 offset:61440
    v_add_u32 v4, 0xfffec000, v4
    ds_read_b128 a[164:167], v4
    buffer_load_dwordx4 v197, s[12:15], s53 offen offset:1024 lds
    v_mfma_f32_32x32x16_bf16 v[144:159], a[152:155], v[180:183], v[144:159]
    v_add_u32 v213, 0xfffec000, v213
    ds_read_b128 a[168:171], v213
    ds_read_b128 v[168:171], v209 offset:57344
    buffer_load_dwordx4 v198, s[12:15], s53 offen offset:2048 lds
    s_waitcnt lgkmcnt(6)
    v_mfma_f32_32x32x16_bf16 v[64:79], v[184:187], a[24:27], v[64:79]
    ds_read_b128 v[172:175], v209 offset:61440
    v_add_u32 v5, 0xfffec000, v5
    ds_read_b128 a[172:175], v5
    v_mfma_f32_32x32x16_bf16 v[96:111], v[188:191], a[24:27], v[96:111]
    v_add_u32 v214, 0xfffec000, v214
    ds_read_b128 a[176:179], v214
    ds_read_b128 v[176:179], v210 offset:57344
    buffer_load_dwordx4 v199, s[12:15], s53 offen offset:3072 lds
    s_add_u32 m0, s3, 0x14000
    v_mfma_f32_32x32x16_bf16 v[80:95], v[184:187], a[28:31], v[80:95]
    ds_read_b128 v[180:183], v210 offset:61440
    v_add_u32 v6, 0xfffec000, v6
    ds_read_b128 a[180:183], v6
    v_mfma_f32_32x32x16_bf16 v[112:127], v[188:191], a[28:31], v[112:127]
    v_add_u32 v215, 0xfffec000, v215
    ds_read_b128 a[184:187], v215
    ds_read_b128 v[184:187], v211 offset:57344
    buffer_load_dwordx4 v196, s[12:15], s54 offen lds
    s_waitcnt lgkmcnt(11)
    v_mfma_f32_32x32x16_bf16 v[128:143], a[160:163], v[160:163], v[128:143]
    ds_read_b128 v[188:191], v211 offset:61440
    v_add_u32 v7, 0xfffec000, v7
    ds_read_b128 a[188:191], v7
    buffer_load_dwordx4 v197, s[12:15], s54 offen offset:1024 lds
    v_mfma_f32_32x32x16_bf16 v[144:159], a[160:163], v[164:167], v[144:159]
    s_waitcnt vmcnt(6)
    s_barrier
    ds_read_b128 a[192:195], v212 offset:16384
    v_add_u32 v208, 0xffff8000, v208
    ds_read_b128 v[160:163], v208
    buffer_load_dwordx4 v198, s[12:15], s54 offen offset:2048 lds
    s_waitcnt lgkmcnt(11)
    v_mfma_f32_32x32x16_bf16 v[128:143], a[168:171], v[168:171], v[128:143]
    ds_read_b128 v[164:167], v208 offset:4096
    ds_read_b128 a[196:199], v4 offset:16384
    buffer_load_dwordx4 v199, s[12:15], s54 offen offset:3072 lds
    s_add_u32 m0, s3, 0x18000
    v_mfma_f32_32x32x16_bf16 v[144:159], a[168:171], v[172:175], v[144:159]
    v_add_u32 v216, 0xffff8000, v216
    ds_read_b64_tr_b16 v[168:169], v216
    ds_read_b64_tr_b16 v[170:171], v216 offset:512
    buffer_load_dwordx4 v196, s[12:15], s55 offen lds
    s_waitcnt lgkmcnt(11)
    v_mfma_f32_32x32x16_bf16 v[128:143], a[176:179], v[176:179], v[128:143]
    ds_read_b64_tr_b16 v[172:173], v216 offset:8192
    ds_read_b64_tr_b16 v[174:175], v216 offset:8704
    buffer_load_dwordx4 v197, s[12:15], s55 offen offset:1024 lds
    v_mfma_f32_32x32x16_bf16 v[144:159], a[176:179], v[180:183], v[144:159]
    buffer_load_dwordx4 v198, s[12:15], s55 offen offset:2048 lds
    s_waitcnt lgkmcnt(9)
    v_mfma_f32_32x32x16_bf16 v[128:143], a[184:187], v[184:187], v[128:143]
    buffer_load_dwordx4 v199, s[12:15], s55 offen offset:3072 lds
    s_add_u32 m0, s3, 0x1c000
    v_mfma_f32_32x32x16_bf16 v[144:159], a[184:187], v[188:191], v[144:159]
    ds_read_b128 a[200:203], v213 offset:16384
    v_add_u32 v209, 0xffff8000, v209
    ds_read_b128 v[176:179], v209
    s_waitcnt lgkmcnt(7)
    v_mfma_f32_32x32x16_bf16 v[128:143], a[192:195], v[160:163], v[128:143]
    ds_read_b128 v[180:183], v209 offset:4096
    ds_read_b128 a[204:207], v5 offset:16384
    v_mfma_f32_32x32x16_bf16 v[144:159], a[192:195], v[164:167], v[144:159]
    ds_read_b64_tr_b16 v[184:185], v216 offset:2048
    ds_read_b64_tr_b16 v[186:187], v216 offset:2560
    s_waitcnt lgkmcnt(6)
    v_mfma_f32_32x32x16_bf16 v[64:79], v[168:171], a[32:35], v[64:79]
    ds_read_b64_tr_b16 v[188:189], v216 offset:10240
    ds_read_b64_tr_b16 v[190:191], v216 offset:10752
    v_mfma_f32_32x32x16_bf16 v[96:111], v[172:175], a[32:35], v[96:111]
    v_mfma_f32_32x32x16_bf16 v[80:95], v[168:171], a[36:39], v[80:95]
    v_mfma_f32_32x32x16_bf16 v[112:127], v[172:175], a[36:39], v[112:127]
    ds_read_b128 a[208:211], v214 offset:16384
    v_add_u32 v210, 0xffff8000, v210
    ds_read_b128 v[160:163], v210
    s_waitcnt lgkmcnt(7)
    v_mfma_f32_32x32x16_bf16 v[128:143], a[200:203], v[176:179], v[128:143]
    ds_read_b128 v[164:167], v210 offset:4096
    ds_read_b128 a[212:215], v6 offset:16384
    v_mfma_f32_32x32x16_bf16 v[144:159], a[200:203], v[180:183], v[144:159]
    ds_read_b64_tr_b16 v[168:169], v216 offset:4096
    ds_read_b64_tr_b16 v[170:171], v216 offset:4608
    s_waitcnt lgkmcnt(6)
    v_mfma_f32_32x32x16_bf16 v[64:79], v[184:187], a[40:43], v[64:79]
    ds_read_b64_tr_b16 v[172:173], v216 offset:12288
    ds_read_b64_tr_b16 v[174:175], v216 offset:12800
    v_mfma_f32_32x32x16_bf16 v[96:111], v[188:191], a[40:43], v[96:111]
    v_mfma_f32_32x32x16_bf16 v[80:95], v[184:187], a[44:47], v[80:95]
    v_mfma_f32_32x32x16_bf16 v[112:127], v[188:191], a[44:47], v[112:127]
    ds_read_b128 a[216:219], v215 offset:16384
    v_add_u32 v211, 0xffff8000, v211
    ds_read_b128 v[176:179], v211
    s_waitcnt lgkmcnt(7)
    v_mfma_f32_32x32x16_bf16 v[128:143], a[208:211], v[160:163], v[128:143]
    ds_read_b128 v[180:183], v211 offset:4096
    ds_read_b128 a[220:223], v7 offset:16384
    v_mfma_f32_32x32x16_bf16 v[144:159], a[208:211], v[164:167], v[144:159]
    ds_read_b64_tr_b16 v[184:185], v216 offset:6144
    ds_read_b64_tr_b16 v[186:187], v216 offset:6656
    s_waitcnt lgkmcnt(6)
    v_mfma_f32_32x32x16_bf16 v[64:79], v[168:171], a[48:51], v[64:79]
    ds_read_b64_tr_b16 v[188:189], v216 offset:14336
    ds_read_b64_tr_b16 v[190:191], v216 offset:14848
    v_mfma_f32_32x32x16_bf16 v[96:111], v[172:175], a[48:51], v[96:111]
    s_waitcnt vmcnt(8)
    s_barrier
    ds_read_b64_tr_b16 v[160:161], v216 offset:16384
    ds_read_b64_tr_b16 v[162:163], v216 offset:16896
    buffer_load_dwordx4 v196, s[12:15], s56 offen lds
    buffer_load_dword v205, v206, s[36:39], 0 offen sc1
    v_mfma_f32_32x32x16_bf16 v[80:95], v[168:171], a[52:55], v[80:95]
    ds_read_b64_tr_b16 v[164:165], v216 offset:24576
    ds_read_b64_tr_b16 v[166:167], v216 offset:25088
    v_mfma_f32_32x32x16_bf16 v[112:127], v[172:175], a[52:55], v[112:127]
    ds_read_b64_tr_b16 v[168:169], v216 offset:18432
    ds_read_b64_tr_b16 v[170:171], v216 offset:18944
    buffer_load_dwordx4 v197, s[12:15], s56 offen offset:1024 lds
    s_waitcnt lgkmcnt(11)
    v_mfma_f32_32x32x16_bf16 v[128:143], a[216:219], v[176:179], v[128:143]
    ds_read_b64_tr_b16 v[172:173], v216 offset:26624
    ds_read_b64_tr_b16 v[174:175], v216 offset:27136
    buffer_load_dwordx4 v198, s[12:15], s56 offen offset:2048 lds
    v_mfma_f32_32x32x16_bf16 v[144:159], a[216:219], v[180:183], v[144:159]
    buffer_load_dwordx4 v199, s[12:15], s56 offen offset:3072 lds
    s_add_u32 m0, s3, 0x20000
    s_waitcnt lgkmcnt(8)
    v_mfma_f32_32x32x16_bf16 v[64:79], v[184:187], a[56:59], v[64:79]
    v_mfma_f32_32x32x16_bf16 v[96:111], v[188:191], a[56:59], v[96:111]
    ds_read_b64_tr_b16 v[176:177], v216 offset:20480
    ds_read_b64_tr_b16 v[178:179], v216 offset:20992
    buffer_load_dwordx4 v196, s[12:15], s57 offen lds
    v_fma_f32 v246, v220, v128, v129
    s_nop 2
    v_fma_f32 v247, v220, v144, v145
    v_fmac_f32 v246, v253, v144
    v_fmac_f32 v247, v221, v128
    v_fma_f32 v248, v220, v246, v130
    v_fma_f32 v249, v220, v247, v146
    v_fmac_f32 v248, v253, v247
    v_fmac_f32 v249, v221, v246
    v_mfma_f32_32x32x16_bf16 v[80:95], v[184:187], a[60:63], v[80:95]
    ds_read_b64_tr_b16 v[180:181], v216 offset:28672
    ds_read_b64_tr_b16 v[182:183], v216 offset:29184
    v_fma_f32 v246, v220, v248, v131
    v_fma_f32 v247, v220, v249, v147
    v_fmac_f32 v246, v253, v249
    v_fmac_f32 v247, v221, v248
    v_fma_f32 v248, v220, v246, v132
    v_fma_f32 v249, v220, v247, v148
    v_fmac_f32 v248, v253, v247
    v_fmac_f32 v249, v221, v246
    v_fma_f32 v246, v220, v248, v133
    v_mfma_f32_32x32x16_bf16 v[112:127], v[188:191], a[60:63], v[112:127]
    buffer_load_dwordx4 v197, s[12:15], s57 offen offset:1024 lds
    v_fma_f32 v247, v220, v249, v149
    v_fmac_f32 v246, v253, v249
    v_fmac_f32 v247, v221, v248
    v_fma_f32 v248, v220, v246, v134
    v_fma_f32 v249, v220, v247, v150
    v_fmac_f32 v248, v253, v247
    v_fmac_f32 v249, v221, v246
    v_fma_f32 v246, v220, v248, v135
    v_fma_f32 v247, v220, v249, v151
    s_waitcnt lgkmcnt(8)
    v_mfma_f32_32x32x16_bf16 v[64:79], v[160:163], a[64:67], v[64:79]
    v_fmac_f32 v246, v253, v249
    v_fmac_f32 v247, v221, v248
    v_fma_f32 v248, v220, v246, v136
    v_fma_f32 v249, v220, v247, v152
    v_fmac_f32 v248, v253, v247
    v_fmac_f32 v249, v221, v246
    v_fma_f32 v246, v220, v248, v137
    v_fma_f32 v247, v220, v249, v153
    v_fmac_f32 v246, v253, v249
    v_fmac_f32 v247, v221, v248
    v_fma_f32 v248, v220, v246, v138
    v_mfma_f32_32x32x16_bf16 v[96:111], v[164:167], a[64:67], v[96:111]
    ds_read_b64_tr_b16 v[184:185], v216 offset:22528
    ds_read_b64_tr_b16 v[186:187], v216 offset:23040
    v_fma_f32 v249, v220, v247, v154
    v_fmac_f32 v248, v253, v247
    v_fmac_f32 v249, v221, v246
    v_fma_f32 v246, v220, v248, v139
    v_fma_f32 v247, v220, v249, v155
    v_fmac_f32 v246, v253, v249
    v_fmac_f32 v247, v221, v248
    v_fma_f32 v248, v220, v246, v140
    v_fma_f32 v249, v220, v247, v156
    v_mfma_f32_32x32x16_bf16 v[80:95], v[160:163], a[68:71], v[80:95]
    ds_read_b64_tr_b16 v[188:189], v216 offset:30720
    ds_read_b64_tr_b16 v[190:191], v216 offset:31232
    buffer_load_dwordx4 v198, s[12:15], s57 offen offset:2048 lds
    v_fmac_f32 v248, v253, v247
    v_fmac_f32 v249, v221, v246
    v_fma_f32 v246, v220, v248, v141
    v_fma_f32 v247, v220, v249, v157
    v_fmac_f32 v246, v253, v249
    v_fmac_f32 v247, v221, v248
    v_fma_f32 v248, v220, v246, v142
    v_fma_f32 v249, v220, v247, v158
    v_mfma_f32_32x32x16_bf16 v[112:127], v[164:167], a[68:71], v[112:127]
    v_fmac_f32 v248, v253, v247
    v_fmac_f32 v249, v221, v246
    v_fma_f32 v234, v220, v248, v143
    v_fma_f32 v235, v220, v249, v159
    v_fmac_f32 v234, v253, v249
    v_fmac_f32 v235, v221, v248
    ds_write_b64 v237, v[234:235] offset:1792
    s_waitcnt lgkmcnt(9)
    v_mfma_f32_32x32x16_bf16 v[64:79], v[168:171], a[72:75], v[64:79]
    v_mfma_f32_32x32x16_bf16 v[96:111], v[172:175], a[72:75], v[96:111]
    s_waitcnt vmcnt(8) lgkmcnt(0)
    s_barrier
    ds_read_b64_tr_b16 v[160:161], v216 offset:32768
    ds_read_b64_tr_b16 v[162:163], v216 offset:33280
    buffer_load_dwordx4 v199, s[12:15], s57 offen offset:3072 lds
    s_add_u32 m0, s3, 0
    ds_read_b64 v[16:17], v237
    ds_read_b64 v[18:19], v237 offset:256
    ds_read_b64 v[20:21], v237 offset:512
    ds_read_b64 v[22:23], v237 offset:768
    ds_read_b64 v[24:25], v237 offset:1024
    v_mfma_f32_32x32x16_bf16 v[80:95], v[168:171], a[76:79], v[80:95]
    ds_read_b64_tr_b16 v[164:165], v216 offset:40960
    ds_read_b64_tr_b16 v[166:167], v216 offset:41472
    ds_read_b64 v[26:27], v237 offset:1280
    ds_read_b64 v[28:29], v237 offset:1536
    v_mfma_f32_32x32x16_bf16 v[112:127], v[172:175], a[76:79], v[112:127]
    v_mfma_f32_32x32x16_bf16 v[64:79], v[176:179], a[80:83], v[64:79]
    v_add_u32 v196, 0x80, v196
    v_add_u32 v197, 0x80, v197
    v_add_u32 v198, 0x80, v198
    v_add_u32 v199, 0x80, v199
    buffer_load_dwordx4 v196, s[12:15], s51 offen lds
    v_mfma_f32_32x32x16_bf16 v[96:111], v[180:183], a[80:83], v[96:111]
    ds_read_b64_tr_b16 v[168:169], v216 offset:34816
    ds_read_b64_tr_b16 v[170:171], v216 offset:35328
    s_waitcnt lgkmcnt(2)
    v_fma_f32 v18, v222, v16, v18
    v_fma_f32 v19, v222, v17, v19
    v_fma_f32 v18, -v223, v17, v18
    v_fma_f32 v19, v223, v16, v19
    v_fma_f32 v20, v222, v18, v20
    v_fma_f32 v21, v222, v19, v21
    v_fma_f32 v20, -v223, v19, v20
    v_fma_f32 v21, v223, v18, v21
    v_fma_f32 v22, v222, v20, v22
    v_mfma_f32_32x32x16_bf16 v[80:95], v[176:179], a[84:87], v[80:95]
    ds_read_b64_tr_b16 v[172:173], v216 offset:43008
    ds_read_b64_tr_b16 v[174:175], v216 offset:43520
    v_fma_f32 v23, v222, v21, v23
    v_fma_f32 v22, -v223, v21, v22
    v_fma_f32 v23, v223, v20, v23
    v_fma_f32 v24, v222, v22, v24
    v_fma_f32 v25, v222, v23, v25
    v_fma_f32 v24, -v223, v23, v24
    v_fma_f32 v25, v223, v22, v25
    v_fma_f32 v26, v222, v24, v26
    v_fma_f32 v27, v222, v25, v27
    v_mfma_f32_32x32x16_bf16 v[112:127], v[180:183], a[84:87], v[112:127]
    buffer_load_dwordx4 v197, s[12:15], s51 offen offset:1024 lds
    v_fma_f32 v26, -v223, v25, v26
    v_fma_f32 v27, v223, v24, v27
    v_fma_f32 v232, v222, v26, v28
    v_fma_f32 v233, v222, v27, v29
    v_fma_f32 v232, -v223, v27, v232
    v_fma_f32 v233, v223, v26, v233
    v_fma_f32 v234, v222, v232, v234
    v_fma_f32 v235, v222, v233, v235
    v_fma_f32 v234, -v223, v233, v234
    v_mfma_f32_32x32x16_bf16 v[64:79], v[184:187], a[88:91], v[64:79]
    v_fma_f32 v235, v223, v232, v235
    v_min_u32 v234, -2, v234
    v_min_u32 v235, -2, v235
    v_mfma_f32_32x32x16_bf16 v[96:111], v[188:191], a[88:91], v[96:111]
    ds_read_b64_tr_b16 v[176:177], v216 offset:36864
    ds_read_b64_tr_b16 v[178:179], v216 offset:37376
    s_waitcnt vmcnt(9)
    v_cmp_ne_u32 vcc, 1, v205
    s_nop 0
    s_cmp_lg_u64 vcc, 0
    s_cbranch_scc1 L_slow_cnt0
L_ret_cnt0:
    buffer_store_dwordx2 v[234:235], v238, s[28:31], 0 offen sc1
    v_mfma_f32_32x32x16_bf16 v[80:95], v[184:187], a[92:95], v[80:95]
    ds_read_b64_tr_b16 v[180:181], v216 offset:45056
    ds_read_b64_tr_b16 v[182:183], v216 offset:45568
    buffer_load_dwordx4 v198, s[12:15], s51 offen offset:2048 lds
    v_mfma_f32_32x32x16_bf16 v[112:127], v[188:191], a[92:95], v[112:127]
    v_mfma_f32_32x32x16_bf16 v[64:79], v[160:163], a[96:99], v[64:79]
    v_mfma_f32_32x32x16_bf16 v[96:111], v[164:167], a[96:99], v[96:111]
    ds_read_b64_tr_b16 v[184:185], v216 offset:38912
    ds_read_b64_tr_b16 v[186:187], v216 offset:39424
    buffer_load_dwordx4 v199, s[12:15], s51 offen offset:3072 lds
    s_add_u32 m0, s3, 0x4000
    v_mfma_f32_32x32x16_bf16 v[80:95], v[160:163], a[100:103], v[80:95]
    ds_read_b64_tr_b16 v[188:189], v216 offset:47104
    ds_read_b64_tr_b16 v[190:191], v216 offset:47616
    v_mfma_f32_32x32x16_bf16 v[112:127], v[164:167], a[100:103], v[112:127]
    s_waitcnt lgkmcnt(8)
    v_mfma_f32_32x32x16_bf16 v[64:79], v[168:171], a[104:107], v[64:79]
    v_accvgpr_read_b32 v192, a232
    v_accvgpr_read_b32 v193, a233
    v_accvgpr_read_b32 v194, a234
    v_accvgpr_read_b32 v195, a235
    buffer_load_dwordx4 v196, s[12:15], s52 offen lds
    v_mfma_f32_32x32x16_bf16 v[96:111], v[172:175], a[104:107], v[96:111]
    ds_read_b64_tr_b16 v[160:161], v216 offset:49152
    ds_read_b64_tr_b16 v[162:163], v216 offset:49664
    v_mfma_f32_32x32x16_bf16 v[80:95], v[168:171], a[108:111], v[80:95]
    ds_read_b64_tr_b16 v[164:165], v216 offset:57344
    ds_read_b64_tr_b16 v[166:167], v216 offset:57856
    v_mfma_f32_32x32x16_bf16 v[112:127], v[172:175], a[108:111], v[112:127]
    buffer_load_dwordx4 v197, s[12:15], s52 offen offset:1024 lds
    s_waitcnt lgkmcnt(8)
    v_mfma_f32_32x32x16_bf16 v[64:79], v[176:179], a[112:115], v[64:79]
    v_mfma_f32_32x32x16_bf16 v[96:111], v[180:183], a[112:115], v[96:111]
    ds_read_b64_tr_b16 v[168:169], v216 offset:51200
    ds_read_b64_tr_b16 v[170:171], v216 offset:51712
    v_mfma_f32_32x32x16_bf16 v[80:95], v[176:179], a[116:119], v[80:95]
    ds_read_b64_tr_b16 v[172:173], v216 offset:59392
    ds_read_b64_tr_b16 v[174:175], v216 offset:59904
    buffer_load_dwordx4 v198, s[12:15], s52 offen offset:2048 lds
    v_mfma_f32_32x32x16_bf16 v[112:127], v[180:183], a[116:119], v[112:127]
    s_waitcnt lgkmcnt(8)
    v_mfma_f32_32x32x16_bf16 v[64:79], v[184:187], a[120:123], v[64:79]
    v_mfma_f32_32x32x16_bf16 v[96:111], v[188:191], a[120:123], v[96:111]
    ds_read_b64_tr_b16 v[176:177], v216 offset:53248
    ds_read_b64_tr_b16 v[178:179], v216 offset:53760
    buffer_load_dwordx4 v199, s[12:15], s52 offen offset:3072 lds
    s_add_u32 m0, s3, 0x8000
    v_mfma_f32_32x32x16_bf16 v[80:95], v[184:187], a[124:127], v[80:95]
    ds_read_b64_tr_b16 v[180:181], v216 offset:61440
    ds_read_b64_tr_b16 v[182:183], v216 offset:61952
    v_mfma_f32_32x32x16_bf16 v[112:127], v[188:191], a[124:127], v[112:127]
    s_waitcnt lgkmcnt(8)
    v_mfma_f32_32x32x16_bf16 v[64:79], v[160:163], a[128:131], v[64:79]
    v_accvgpr_read_b32 v200, a236
    v_accvgpr_read_b32 v201, a237
    v_accvgpr_read_b32 v202, a238
    v_accvgpr_read_b32 v203, a239
    buffer_load_dwordx4 v196, s[12:15], s53 offen lds
    v_mfma_f32_32x32x16_bf16 v[96:111], v[164:167], a[128:131], v[96:111]
    ds_read_b64_tr_b16 v[184:185], v216 offset:55296
    ds_read_b64_tr_b16 v[186:187], v216 offset:55808
    v_mfma_f32_32x32x16_bf16 v[80:95], v[160:163], a[132:135], v[80:95]
    ds_read_b64_tr_b16 v[188:189], v216 offset:63488
    ds_read_b64_tr_b16 v[190:191], v216 offset:64000
    v_mfma_f32_32x32x16_bf16 v[112:127], v[164:167], a[132:135], v[112:127]
    buffer_load_dwordx4 v197, s[12:15], s53 offen offset:1024 lds
    s_waitcnt lgkmcnt(8)
    v_mfma_f32_32x32x16_bf16 v[64:79], v[168:171], a[136:139], v[64:79]
    v_mfma_f32_32x32x16_bf16 v[96:111], v[172:175], a[136:139], v[96:111]
    s_waitcnt vmcnt(11) lgkmcnt(0)
    s_barrier
    v_add_u32 v216, 0x8000, v216
    ds_read_b64_tr_b16 v[160:161], v216 offset:32768
    ds_read_b64_tr_b16 v[162:163], v216 offset:33280
    v_mfma_f32_32x32x16_bf16 v[80:95], v[168:171], a[140:143], v[80:95]
    ds_read_b64_tr_b16 v[164:165], v216 offset:40960
    ds_read_b64_tr_b16 v[166:167], v216 offset:41472
    buffer_load_dwordx4 v198, s[12:15], s53 offen offset:2048 lds
    v_mfma_f32_32x32x16_bf16 v[112:127], v[172:175], a[140:143], v[112:127]
    s_lshl_b32 s78, s63, 10
    s_add_u32 m0, s78, 0x24000
    s_nop 0
    buffer_load_dwordx4 v239, s[28:31], 0 offen sc1 lds
    s_add_u32 m0, s3, 0x8000
    v_mfma_f32_32x32x16_bf16 v[64:79], v[176:179], a[144:147], v[64:79]
    v_and_b32 v246, 31, v245
    v_lshrrev_b32 v247, 5, v245
    v_lshlrev_b32 v246, 3, v246
    v_lshl_add_u32 v246, v247, 11, v246
    v_add_u32 v247, 0x24000, v246
    v_mfma_f32_32x32x16_bf16 v[96:111], v[180:183], a[144:147], v[96:111]
    ds_read_b64_tr_b16 v[168:169], v216 offset:34816
    ds_read_b64_tr_b16 v[170:171], v216 offset:35328
    buffer_load_dwordx4 v199, s[12:15], s53 offen offset:3072 lds
    s_add_u32 m0, s3, 0xc000
    v_mfma_f32_32x32x16_bf16 v[80:95], v[176:179], a[148:151], v[80:95]
    ds_read_b64_tr_b16 v[172:173], v216 offset:43008
    ds_read_b64_tr_b16 v[174:175], v216 offset:43520
    v_mfma_f32_32x32x16_bf16 v[112:127], v[180:183], a[148:151], v[112:127]
    v_mfma_f32_32x32x16_bf16 v[64:79], v[184:187], a[152:155], v[64:79]
    s_mul_i32 s44, s90, s97
    s_mul_i32 s45, s91, s97
    s_mul_i32 s46, s92, s97
    s_mul_i32 s47, s93, s97
    buffer_load_dwordx4 v196, s[12:15], s54 offen lds
    v_mfma_f32_32x32x16_bf16 v[96:111], v[188:191], a[152:155], v[96:111]
    ds_read_b64_tr_b16 v[176:177], v216 offset:36864
    ds_read_b64_tr_b16 v[178:179], v216 offset:37376
    v_mfma_f32_32x32x16_bf16 v[80:95], v[184:187], a[156:159], v[80:95]
    ds_read_b64_tr_b16 v[180:181], v216 offset:45056
    ds_read_b64_tr_b16 v[182:183], v216 offset:45568
    v_mfma_f32_32x32x16_bf16 v[112:127], v[188:191], a[156:159], v[112:127]
    buffer_load_dwordx4 v197, s[12:15], s54 offen offset:1024 lds
    s_waitcnt lgkmcnt(8)
    v_mfma_f32_32x32x16_bf16 v[64:79], v[160:163], a[160:163], v[64:79]
    v_mfma_f32_32x32x16_bf16 v[96:111], v[164:167], a[160:163], v[96:111]
    ds_read_b64_tr_b16 v[184:185], v216 offset:38912
    ds_read_b64_tr_b16 v[186:187], v216 offset:39424
    v_mfma_f32_32x32x16_bf16 v[80:95], v[160:163], a[164:167], v[80:95]
    ds_read_b64_tr_b16 v[188:189], v216 offset:47104
    ds_read_b64_tr_b16 v[190:191], v216 offset:47616
    buffer_load_dwordx4 v198, s[12:15], s54 offen offset:2048 lds
    v_mfma_f32_32x32x16_bf16 v[112:127], v[164:167], a[164:167], v[112:127]
    s_waitcnt lgkmcnt(8)
    v_mfma_f32_32x32x16_bf16 v[64:79], v[168:171], a[168:171], v[64:79]
    v_mfma_f32_32x32x16_bf16 v[96:111], v[172:175], a[168:171], v[96:111]
    ds_read_b64_tr_b16 v[160:161], v216 offset:49152
    ds_read_b64_tr_b16 v[162:163], v216 offset:49664
    buffer_load_dwordx4 v199, s[12:15], s54 offen offset:3072 lds
    s_add_u32 m0, s3, 0x10000
    v_mfma_f32_32x32x16_bf16 v[80:95], v[168:171], a[172:175], v[80:95]
    ds_read_b64_tr_b16 v[164:165], v216 offset:57344
    ds_read_b64_tr_b16 v[166:167], v216 offset:57856
    v_mfma_f32_32x32x16_bf16 v[112:127], v[172:175], a[172:175], v[112:127]
    s_waitcnt lgkmcnt(8)
    v_mfma_f32_32x32x16_bf16 v[64:79], v[176:179], a[176:179], v[64:79]
    s_mul_i32 s48, s94, s97
    s_mul_i32 s49, s95, s97
    s_mul_i32 s50, s96, s97
    buffer_load_dwordx4 v196, s[12:15], s55 offen lds
    v_mfma_f32_32x32x16_bf16 v[96:111], v[180:183], a[176:179], v[96:111]
    ds_read_b64_tr_b16 v[168:169], v216 offset:51200
    ds_read_b64_tr_b16 v[170:171], v216 offset:51712
    v_mfma_f32_32x32x16_bf16 v[80:95], v[176:179], a[180:183], v[80:95]
    ds_read_b64_tr_b16 v[172:173], v216 offset:59392
    ds_read_b64_tr_b16 v[174:175], v216 offset:59904
    v_mfma_f32_32x32x16_bf16 v[112:127], v[180:183], a[180:183], v[112:127]
    s_waitcnt vmcnt(6)
    s_barrier
    buffer_load_dwordx4 v197, s[12:15], s55 offen offset:1024 lds
    buffer_load_dword v205, v206, s[36:39], 0 offen offset:128 sc1
    ds_read_b64 v[16:17], v247
    ds_read_b64 v[18:19], v247 offset:256
    ds_read_b64 v[20:21], v247 offset:512
    ds_read_b64 v[22:23], v247 offset:768
    s_waitcnt lgkmcnt(12)
    v_mfma_f32_32x32x16_bf16 v[64:79], v[184:187], a[184:187], v[64:79]
    ds_read_b64 v[24:25], v247 offset:1024
    ds_read_b64 v[26:27], v247 offset:1280
    ds_read_b64 v[28:29], v247 offset:1536
    ds_read_b64 v[30:31], v247 offset:1792
    v_mfma_f32_32x32x16_bf16 v[96:111], v[188:191], a[184:187], v[96:111]
    ds_read_b64_tr_b16 v[176:177], v216 offset:53248
    ds_read_b64_tr_b16 v[178:179], v216 offset:53760
    v_mfma_f32_32x32x16_bf16 v[80:95], v[184:187], a[188:191], v[80:95]
    ds_read_b64_tr_b16 v[180:181], v216 offset:61440
    ds_read_b64_tr_b16 v[182:183], v216 offset:61952
    buffer_load_dwordx4 v198, s[12:15], s55 offen offset:2048 lds
    v_mfma_f32_32x32x16_bf16 v[112:127], v[188:191], a[188:191], v[112:127]
    s_waitcnt lgkmcnt(14)
    v_mfma_f32_32x32x16_bf16 v[64:79], v[160:163], a[192:195], v[64:79]
    s_waitcnt lgkmcnt(4)
    v_max3_u32 v246, v16, v30, v31
    v_max3_u32 v246, v246, v17, v18
    v_max3_u32 v246, v246, v19, v20
    v_max3_u32 v246, v246, v21, v22
    v_max3_u32 v246, v246, v23, v24
    v_max3_u32 v246, v246, v25, v26
    v_max3_u32 v246, v246, v27, v28
    v_max_u32 v246, v246, v29
    v_cmp_eq_u32 vcc, -1, v246
    s_nop 0
    s_cmp_lg_u64 vcc, 0
    s_cbranch_scc1 L_slow_lb
L_ret_lb:
    s_add_u32 m0, s3, 0x10000
    v_mfma_f32_32x32x16_bf16 v[96:111], v[164:167], a[192:195], v[96:111]
    ds_read_b64_tr_b16 v[184:185], v216 offset:55296
    ds_read_b64_tr_b16 v[186:187], v216 offset:55808
    buffer_load_dwordx4 v199, s[12:15], s55 offen offset:3072 lds
    s_add_u32 m0, s3, 0x14000
    v_fma_f32 v28, v224, v30, v28
    v_fma_f32 v29, v224, v31, v29
    v_fma_f32 v28, -v225, v31, v28
    v_fma_f32 v29, v225, v30, v29
    v_fma_f32 v26, v224, v28, v26
    v_fma_f32 v27, v224, v29, v27
    v_mfma_f32_32x32x16_bf16 v[80:95], v[160:163], a[196:199], v[80:95]
    ds_read_b64_tr_b16 v[188:189], v216 offset:63488
    ds_read_b64_tr_b16 v[190:191], v216 offset:64000
    v_fma_f32 v26, -v225, v29, v26
    v_fma_f32 v27, v225, v28, v27
    v_fma_f32 v24, v224, v26, v24
    v_fma_f32 v25, v224, v27, v25
    v_fma_f32 v24, -v225, v27, v24
    v_fma_f32 v25, v225, v26, v25
    v_fma_f32 v22, v224, v24, v22
    v_fma_f32 v23, v224, v25, v23
    v_mfma_f32_32x32x16_bf16 v[112:127], v[164:167], a[196:199], v[112:127]
    v_fma_f32 v22, -v225, v25, v22
    v_fma_f32 v23, v225, v24, v23
    v_fma_f32 v20, v224, v22, v20
    v_fma_f32 v21, v224, v23, v21
    v_fma_f32 v20, -v225, v23, v20
    v_fma_f32 v21, v225, v22, v21
    v_fma_f32 v18, v224, v20, v18
    v_fma_f32 v19, v224, v21, v19
    v_fma_f32 v18, -v225, v21, v18
    v_mfma_f32_32x32x16_bf16 v[64:79], v[168:171], a[200:203], v[64:79]
    buffer_load_dwordx4 v196, s[12:15], s56 offen lds
    v_fma_f32 v19, v225, v20, v19
    v_fma_f32 v16, v224, v18, v16
    v_fma_f32 v17, v224, v19, v17
    v_fma_f32 v16, -v225, v19, v16
    v_fma_f32 v17, v225, v18, v17
    v_mov_b32 v18, v16
    v_mov_b32 v19, v17
    s_nop 0
    v_permlane32_swap_b32 v16, v18
    v_mfma_f32_32x32x16_bf16 v[96:111], v[172:175], a[200:203], v[96:111]
    s_waitcnt lgkmcnt(0)
    s_barrier
    v_add_u32 v216, 0xfffec000, v216
    ds_read_b64_tr_b16 v[160:161], v216
    ds_read_b64_tr_b16 v[162:163], v216 offset:512
    v_permlane32_swap_b32 v17, v19
    v_fma_f32 v16, v226, v18, v16
    v_fma_f32 v17, v226, v19, v17
    v_fma_f32 v16, -v227, v19, v16
    v_fma_f32 v17, v227, v18, v17
    v_mfma_f32_32x32x16_bf16 v[80:95], v[168:171], a[204:207], v[80:95]
    ds_read_b64_tr_b16 v[164:165], v216 offset:8192
    ds_read_b64_tr_b16 v[166:167], v216 offset:8704
    v_fma_f32 v232, v228, v16, v232
    v_fma_f32 v233, v228, v17, v233
    v_fma_f32 v232, -v229, v17, v232
    v_fma_f32 v233, v229, v16, v233
    v_fmac_f32 v128, v220, v232
    v_fmac_f32 v144, v220, v233
    v_fmac_f32 v128, v253, v233
    v_fmac_f32 v144, v221, v232
    v_mfma_f32_32x32x16_bf16 v[112:127], v[172:175], a[204:207], v[112:127]
    buffer_load_dwordx4 v197, s[12:15], s56 offen offset:1024 lds
    s_waitcnt vmcnt(4)
    v_cmp_ne_u32 vcc, 1, v205
    s_nop 0
    s_cmp_lg_u64 vcc, 0
    s_cbranch_scc1 L_slow_cnt1
L_ret_cnt1:
    v_mul_f32 v246, v230, v128
    v_mul_f32 v247, v252, v144
    v_fmac_f32 v246, v231, v144
    v_fmac_f32 v247, v231, v128
    v_fmac_f32 v129, v220, v128
    v_mfma_f32_32x32x16_bf16 v[64:79], v[176:179], a[208:211], v[64:79]
    v_and_b32 v250, 3, v245
    v_bfe_u32 v251, v245, 2, 1
    v_lshl_add_u32 v250, v251, 4, v250
    v_bfe_u32 v251, v245, 3, 2
    v_lshl_add_u32 v250, v251, 2, v250
    s_lshl_b32 s100, s59, 1
    s_add_u32 s100, s100, s61
    s_lshl_b32 s100, s100, 1
    v_fmac_f32 v145, v220, v144
    v_fmac_f32 v129, v253, v144
    v_mfma_f32_32x32x16_bf16 v[96:111], v[180:183], a[208:211], v[96:111]
    ds_read_b64_tr_b16 v[168:169], v216 offset:2048
    ds_read_b64_tr_b16 v[170:171], v216 offset:2560
    s_add_u32 s100, s100, s99
    s_lshl_b32 s100, s100, 7
    s_add_u32 s100, s100, 0xb18000
    v_lshlrev_b32 v250, 2, v250
    s_xor_b32 s71, s100, 0x100
    buffer_load_dword v238, v250, s[24:27], s100 offen sc1
    v_fmac_f32 v145, v221, v128
    v_mul_f32 v248, v230, v129
    v_mfma_f32_32x32x16_bf16 v[80:95], v[176:179], a[212:215], v[80:95]
    ds_read_b64_tr_b16 v[172:173], v216 offset:10240
    ds_read_b64_tr_b16 v[174:175], v216 offset:10752
    buffer_load_dwordx4 v198, s[12:15], s56 offen offset:2048 lds
    buffer_load_dword v236, v250, s[24:27], s71 offen sc1
    v_mul_f32 v249, v252, v145
    v_fmac_f32 v248, v231, v145
    v_fmac_f32 v249, v231, v129
    v_cvt_pk_bf16_f32 v128, v246, v248
    v_cvt_pk_bf16_f32 v144, v247, v249
    v_fmac_f32 v130, v220, v129
    v_mfma_f32_32x32x16_bf16 v[112:127], v[180:183], a[212:215], v[112:127]
    v_fmac_f32 v146, v220, v145
    v_fmac_f32 v130, v253, v145
    v_fmac_f32 v146, v221, v129
    v_mul_f32 v246, v230, v130
    v_mul_f32 v247, v252, v146
    v_fmac_f32 v246, v231, v146
    v_fmac_f32 v247, v231, v130
    v_fmac_f32 v131, v220, v130
    v_fmac_f32 v147, v220, v146
    v_mfma_f32_32x32x16_bf16 v[64:79], v[184:187], a[216:219], v[64:79]
    v_fmac_f32 v131, v253, v146
    v_fmac_f32 v147, v221, v130
    v_mul_f32 v248, v230, v131
    v_mul_f32 v249, v252, v147
    v_fmac_f32 v248, v231, v147
    v_fmac_f32 v249, v231, v131
    v_cvt_pk_bf16_f32 v129, v246, v248
    v_cvt_pk_bf16_f32 v145, v247, v249
    v_fmac_f32 v132, v220, v131
    v_fmac_f32 v148, v220, v147
    v_mfma_f32_32x32x16_bf16 v[96:111], v[188:191], a[216:219], v[96:111]
    ds_read_b64_tr_b16 v[176:177], v216 offset:4096
    ds_read_b64_tr_b16 v[178:179], v216 offset:4608
    buffer_load_dwordx4 v199, s[12:15], s56 offen offset:3072 lds
    s_add_u32 m0, s3, 0x18000
    v_fmac_f32 v132, v253, v147
    v_fmac_f32 v148, v221, v131
    v_mul_f32 v246, v230, v132
    v_mul_f32 v247, v252, v148
    v_fmac_f32 v246, v231, v148
    v_fmac_f32 v247, v231, v132
    v_mfma_f32_32x32x16_bf16 v[80:95], v[184:187], a[220:223], v[80:95]
    ds_read_b64_tr_b16 v[180:181], v216 offset:12288
    ds_read_b64_tr_b16 v[182:183], v216 offset:12800
    v_fmac_f32 v133, v220, v132
    v_fmac_f32 v149, v220, v148
    v_fmac_f32 v133, v253, v148
    v_fmac_f32 v149, v221, v132
    v_mul_f32 v248, v230, v133
    v_mul_f32 v249, v252, v149
    v_fmac_f32 v248, v231, v149
    v_fmac_f32 v249, v231, v133
    v_mfma_f32_32x32x16_bf16 v[112:127], v[188:191], a[220:223], v[112:127]
    v_cvt_pk_bf16_f32 v132, v246, v248
    v_cvt_pk_bf16_f32 v148, v247, v249
    v_fmac_f32 v134, v220, v133
    v_fmac_f32 v150, v220, v149
    v_fmac_f32 v134, v253, v149
    v_fmac_f32 v150, v221, v133
    v_mul_f32 v246, v230, v134
    v_mul_f32 v247, v252, v150
    v_fmac_f32 v246, v231, v150
    s_waitcnt lgkmcnt(8)
    v_mfma_f32_32x32x16_bf16 v[0:15], v[160:163], a[0:3], 0
    buffer_load_dwordx4 v196, s[12:15], s57 offen lds
    v_fmac_f32 v247, v231, v134
    v_fmac_f32 v135, v220, v134
    v_fmac_f32 v151, v220, v150
    v_fmac_f32 v135, v253, v150
    v_fmac_f32 v151, v221, v134
    v_mul_f32 v248, v230, v135
    v_mul_f32 v249, v252, v151
    v_fmac_f32 v248, v231, v151
    v_fmac_f32 v249, v231, v135
    v_mfma_f32_32x32x16_bf16 v[32:47], v[164:167], a[0:3], 0
    ds_read_b64_tr_b16 v[184:185], v216 offset:6144
    ds_read_b64_tr_b16 v[186:187], v216 offset:6656
    v_cvt_pk_bf16_f32 v133, v246, v248
    v_cvt_pk_bf16_f32 v149, v247, v249
    v_fmac_f32 v136, v220, v135
    v_fmac_f32 v152, v220, v151
    v_fmac_f32 v136, v253, v151
    v_fmac_f32 v152, v221, v135
    v_mul_f32 v246, v230, v136
    v_mul_f32 v247, v252, v152
    v_mfma_f32_32x32x16_bf16 v[16:31], v[160:163], a[4:7], 0
    ds_read_b64_tr_b16 v[188:189], v216 offset:14336
    ds_read_b64_tr_b16 v[190:191], v216 offset:14848
    v_fmac_f32 v246, v231, v152
    v_fmac_f32 v247, v231, v136
    v_fmac_f32 v137, v220, v136
    v_fmac_f32 v153, v220, v152
    v_fmac_f32 v137, v253, v152
    v_fmac_f32 v153, v221, v136
    v_mul_f32 v248, v230, v137
    v_mul_f32 v249, v252, v153
    v_mfma_f32_32x32x16_bf16 v[48:63], v[164:167], a[4:7], 0
    buffer_load_dwordx4 v197, s[12:15], s57 offen offset:1024 lds
    v_fmac_f32 v248, v231, v153
    v_fmac_f32 v249, v231, v137
    v_cvt_pk_bf16_f32 v136, v246, v248
    v_cvt_pk_bf16_f32 v152, v247, v249
    v_fmac_f32 v138, v220, v137
    v_fmac_f32 v154, v220, v153
    v_fmac_f32 v138, v253, v153
    v_fmac_f32 v154, v221, v137
    s_waitcnt lgkmcnt(8)
    v_mfma_f32_32x32x16_bf16 v[0:15], v[168:171], a[8:11], v[0:15]
    v_mul_f32 v246, v230, v138
    v_mul_f32 v247, v252, v154
    v_fmac_f32 v246, v231, v154
    v_fmac_f32 v247, v231, v138
    v_fmac_f32 v139, v220, v138
    v_fmac_f32 v155, v220, v154
    v_fmac_f32 v139, v253, v154
    v_fmac_f32 v155, v221, v138
    v_mul_f32 v248, v230, v139
    v_mul_f32 v249, v252, v155
    v_mfma_f32_32x32x16_bf16 v[32:47], v[172:175], a[8:11], v[32:47]
    ds_read_b64_tr_b16 v[160:161], v216 offset:16384
    ds_read_b64_tr_b16 v[162:163], v216 offset:16896
    v_fmac_f32 v248, v231, v155
    v_fmac_f32 v249, v231, v139
    v_cvt_pk_bf16_f32 v137, v246, v248
    v_cvt_pk_bf16_f32 v153, v247, v249
    v_fmac_f32 v140, v220, v139
    v_fmac_f32 v156, v220, v155
    v_fmac_f32 v140, v253, v155
    v_fmac_f32 v156, v221, v139
    v_mfma_f32_32x32x16_bf16 v[16:31], v[168:171], a[12:15], v[16:31]
    ds_read_b64_tr_b16 v[164:165], v216 offset:24576
    ds_read_b64_tr_b16 v[166:167], v216 offset:25088
    buffer_load_dwordx4 v198, s[12:15], s57 offen offset:2048 lds
    v_mul_f32 v246, v230, v140
    v_mul_f32 v247, v252, v156
    v_fmac_f32 v246, v231, v156
    v_fmac_f32 v247, v231, v140
    v_fmac_f32 v141, v220, v140
    v_fmac_f32 v157, v220, v156
    v_fmac_f32 v141, v253, v156
    v_mfma_f32_32x32x16_bf16 v[48:63], v[172:175], a[12:15], v[48:63]
    v_fmac_f32 v157, v221, v140
    v_mul_f32 v248, v230, v141
    v_mul_f32 v249, v252, v157
    v_fmac_f32 v248, v231, v157
    v_fmac_f32 v249, v231, v141
    v_cvt_pk_bf16_f32 v140, v246, v248
    v_cvt_pk_bf16_f32 v156, v247, v249
    v_fmac_f32 v142, v220, v141
    v_fmac_f32 v158, v220, v157
    s_waitcnt lgkmcnt(8)
    v_mfma_f32_32x32x16_bf16 v[0:15], v[176:179], a[16:19], v[0:15]
    v_fmac_f32 v142, v253, v157
    v_fmac_f32 v158, v221, v141
    v_mul_f32 v246, v230, v142
    v_mul_f32 v247, v252, v158
    v_fmac_f32 v246, v231, v158
    v_fmac_f32 v247, v231, v142
    v_fmac_f32 v143, v220, v142
    v_fmac_f32 v159, v220, v158
    v_fmac_f32 v143, v253, v158
    v_fmac_f32 v159, v221, v142
    v_mfma_f32_32x32x16_bf16 v[32:47], v[180:183], a[16:19], v[32:47]
    ds_read_b64_tr_b16 v[168:169], v216 offset:18432
    ds_read_b64_tr_b16 v[170:171], v216 offset:18944
    buffer_load_dwordx4 v199, s[12:15], s57 offen offset:3072 lds
    s_add_u32 m0, s3, 0x1c000
    v_mul_f32 v248, v230, v143
    v_mul_f32 v249, v252, v159
    v_fmac_f32 v248, v231, v159
    v_fmac_f32 v249, v231, v143
    v_cvt_pk_bf16_f32 v141, v246, v248
    v_cvt_pk_bf16_f32 v157, v247, v249
    v_mfma_f32_32x32x16_bf16 v[16:31], v[176:179], a[20:23], v[16:31]
    ds_read_b64_tr_b16 v[172:173], v216 offset:26624
    ds_read_b64_tr_b16 v[174:175], v216 offset:27136
    ds_write_b64 v243, v[128:129]
    ds_write_b64 v243, v[132:133] offset:16
    ds_write_b64 v243, v[136:137] offset:32
    ds_write_b64 v243, v[140:141] offset:48
    v_mfma_f32_32x32x16_bf16 v[48:63], v[180:183], a[20:23], v[48:63]
    ds_read_b64_tr_b16 v[128:129], v244
    ds_read_b64_tr_b16 v[130:131], v244 offset:288
    ds_read_b64_tr_b16 v[132:133], v244 offset:1152
    ds_read_b64_tr_b16 v[134:135], v244 offset:1440
    ds_write_b64 v243, v[144:145]
    ds_write_b64 v243, v[148:149] offset:16
    s_waitcnt lgkmcnt(14)
    v_mfma_f32_32x32x16_bf16 v[0:15], v[184:187], a[24:27], v[0:15]
    buffer_load_dwordx4 v192, s[20:23], s44 offen lds
    ds_write_b64 v243, v[152:153] offset:32
    ds_write_b64 v243, v[156:157] offset:48
    ds_read_b64_tr_b16 v[136:137], v244
    ds_read_b64_tr_b16 v[138:139], v244 offset:288
    ds_read_b64_tr_b16 v[140:141], v244 offset:1152
    ds_read_b64_tr_b16 v[142:143], v244 offset:1440
    s_add_u32 s71, s76, 0x7000
    v_mfma_f32_32x32x16_bf16 v[32:47], v[188:191], a[24:27], v[32:47]
    ds_read_b64_tr_b16 v[176:177], v216 offset:20480
    ds_read_b64_tr_b16 v[178:179], v216 offset:20992
    v_mul_f32 v64, s1, v64
    v_mul_f32 v65, s1, v65
    v_exp_f32 v64, v64
    v_mul_f32 v66, s1, v66
    v_mfma_f32_32x32x16_bf16 v[16:31], v[184:187], a[28:31], v[16:31]
    ds_read_b64_tr_b16 v[180:181], v216 offset:28672
    ds_read_b64_tr_b16 v[182:183], v216 offset:29184
    v_exp_f32 v65, v65
    v_add_f32 v64, 1.0, v64
    v_mul_f32 v67, s1, v67
    v_exp_f32 v66, v66
    v_mfma_f32_32x32x16_bf16 v[48:63], v[188:191], a[28:31], v[48:63]
    buffer_load_dwordx4 v193, s[20:23], s44 offen offset:1024 lds
    v_add_f32 v65, 1.0, v65
    v_rcp_f32 v64, v64
    v_mul_f32 v68, s1, v68
    v_exp_f32 v67, v67
    v_mfma_f32_32x32x16_bf16 v[0:15], v[160:163], a[32:35], v[0:15]
    v_add_f32 v66, 1.0, v66
    v_rcp_f32 v65, v65
    v_mul_f32 v64, v64, v96
    v_mul_f32 v69, s1, v69
    v_exp_f32 v68, v68
    v_add_f32 v67, 1.0, v67
    v_mfma_f32_32x32x16_bf16 v[32:47], v[164:167], a[32:35], v[32:47]
    ds_read_b64_tr_b16 v[184:185], v216 offset:22528
    ds_read_b64_tr_b16 v[186:187], v216 offset:23040
    s_waitcnt lgkmcnt(14)
    buffer_store_dwordx4 v[128:131], v218, s[24:27], s76 offen sc1
    v_rcp_f32 v66, v66
    v_mul_f32 v65, v65, v97
    v_mul_f32 v70, s1, v70
    v_mfma_f32_32x32x16_bf16 v[16:31], v[160:163], a[36:39], v[16:31]
    ds_read_b64_tr_b16 v[188:189], v216 offset:30720
    ds_read_b64_tr_b16 v[190:191], v216 offset:31232
    buffer_load_dwordx4 v194, s[20:23], s44 offen offset:2048 lds
    v_exp_f32 v69, v69
    v_add_f32 v68, 1.0, v68
    v_rcp_f32 v67, v67
    v_mfma_f32_32x32x16_bf16 v[48:63], v[164:167], a[36:39], v[48:63]
    buffer_store_dwordx4 v[132:135], v218, s[24:27], s76 offen offset:1024 sc1
    v_mul_f32 v66, v66, v98
    v_mul_f32 v71, s1, v71
    v_exp_f32 v70, v70
    v_add_f32 v69, 1.0, v69
    v_mfma_f32_32x32x16_bf16 v[0:15], v[168:171], a[40:43], v[0:15]
    v_rcp_f32 v68, v68
    v_mul_f32 v67, v67, v99
    v_mul_f32 v72, s1, v72
    v_exp_f32 v71, v71
    v_add_f32 v70, 1.0, v70
    v_mfma_f32_32x32x16_bf16 v[32:47], v[172:175], a[40:43], v[32:47]
    s_waitcnt lgkmcnt(0)
    s_barrier
    ds_read_b64_tr_b16 v[160:161], v216 offset:32768
    ds_read_b64_tr_b16 v[162:163], v216 offset:33280
    buffer_load_dwordx4 v195, s[20:23], s44 offen offset:3072 lds
    s_add_u32 m0, s3, 0x20000
    buffer_store_dwordx4 v[136:139], v218, s[24:27], s71 offen sc1
    v_mfma_f32_32x32x16_bf16 v[16:31], v[168:171], a[44:47], v[16:31]
    ds_read_b64_tr_b16 v[164:165], v216 offset:40960
    ds_read_b64_tr_b16 v[166:167], v216 offset:41472
    v_rcp_f32 v69, v69
    v_mul_f32 v68, v68, v100
    v_mul_f32 v73, s1, v73
    v_exp_f32 v72, v72
    v_mfma_f32_32x32x16_bf16 v[48:63], v[172:175], a[44:47], v[48:63]
    buffer_store_dwordx4 v[140:143], v218, s[24:27], s71 offen offset:1024 sc1
    v_add_f32 v71, 1.0, v71
    v_rcp_f32 v70, v70
    v_mul_f32 v69, v69, v101
    v_mul_f32 v74, s1, v74
    v_mfma_f32_32x32x16_bf16 v[0:15], v[176:179], a[48:51], v[0:15]
    s_mul_i32 s51, s90, 0x700
    s_mul_i32 s52, s91, 0x700
    s_mul_i32 s53, s92, 0x700
    s_mul_i32 s54, s93, 0x700
    buffer_load_dwordx4 v192, s[20:23], s45 offen lds
    v_exp_f32 v73, v73
    v_add_f32 v72, 1.0, v72
    v_mfma_f32_32x32x16_bf16 v[32:47], v[180:183], a[48:51], v[32:47]
    ds_read_b64_tr_b16 v[168:169], v216 offset:34816
    ds_read_b64_tr_b16 v[170:171], v216 offset:35328
    v_rcp_f32 v71, v71
    v_mul_f32 v70, v70, v102
    v_mul_f32 v75, s1, v75
    v_exp_f32 v74, v74
    v_mfma_f32_32x32x16_bf16 v[16:31], v[176:179], a[52:55], v[16:31]
    ds_read_b64_tr_b16 v[172:173], v216 offset:43008
    ds_read_b64_tr_b16 v[174:175], v216 offset:43520
    v_add_f32 v73, 1.0, v73
    v_rcp_f32 v72, v72
    v_mul_f32 v71, v71, v103
    v_cvt_pk_bf16_f32 v96, v64, v65
    v_cvt_pk_bf16_f32 v97, v66, v67
    v_mfma_f32_32x32x16_bf16 v[48:63], v[180:183], a[52:55], v[48:63]
    buffer_load_dwordx4 v193, s[20:23], s45 offen offset:1024 lds
    v_cvt_pk_bf16_f32 v98, v68, v69
    v_cvt_pk_bf16_f32 v99, v70, v71
    v_mul_f32 v76, s1, v76
    v_exp_f32 v75, v75
    v_add_f32 v74, 1.0, v74
    v_mfma_f32_32x32x16_bf16 v[0:15], v[184:187], a[56:59], v[0:15]
    v_rcp_f32 v73, v73
    v_mul_f32 v72, v72, v104
    v_mul_f32 v77, s1, v77
    v_exp_f32 v76, v76
    v_add_f32 v75, 1.0, v75
    v_mfma_f32_32x32x16_bf16 v[32:47], v[188:191], a[56:59], v[32:47]
    ds_read_b64_tr_b16 v[176:177], v216 offset:36864
    ds_read_b64_tr_b16 v[178:179], v216 offset:37376
    v_rcp_f32 v74, v74
    v_mul_f32 v73, v73, v105
    v_mul_f32 v78, s1, v78
    v_exp_f32 v77, v77
    v_mfma_f32_32x32x16_bf16 v[16:31], v[184:187], a[60:63], v[16:31]
    ds_read_b64_tr_b16 v[180:181], v216 offset:45056
    ds_read_b64_tr_b16 v[182:183], v216 offset:45568
    buffer_load_dwordx4 v194, s[20:23], s45 offen offset:2048 lds
    v_add_f32 v76, 1.0, v76
    v_rcp_f32 v75, v75
    v_mul_f32 v74, v74, v106
    v_mul_f32 v79, s1, v79
    v_mfma_f32_32x32x16_bf16 v[48:63], v[188:191], a[60:63], v[48:63]
    v_exp_f32 v78, v78
    v_add_f32 v77, 1.0, v77
    v_rcp_f32 v76, v76
    v_mul_f32 v75, v75, v107
    v_mul_f32 v80, s1, v80
    s_waitcnt lgkmcnt(8)
    v_mfma_f32_32x32x16_bf16 v[0:15], v[160:163], a[64:67], v[0:15]
    v_exp_f32 v79, v79
    v_add_f32 v78, 1.0, v78
    v_rcp_f32 v77, v77
    v_mul_f32 v76, v76, v108
    v_mul_f32 v81, s1, v81
    v_mfma_f32_32x32x16_bf16 v[32:47], v[164:167], a[64:67], v[32:47]
    ds_read_b64_tr_b16 v[184:185], v216 offset:38912
    ds_read_b64_tr_b16 v[186:187], v216 offset:39424
    buffer_load_dwordx4 v195, s[20:23], s45 offen offset:3072 lds
    s_add_u32 m0, s3, 0
    v_exp_f32 v80, v80
    v_add_f32 v79, 1.0, v79
    v_mfma_f32_32x32x16_bf16 v[16:31], v[160:163], a[68:71], v[16:31]
    ds_read_b64_tr_b16 v[188:189], v216 offset:47104
    ds_read_b64_tr_b16 v[190:191], v216 offset:47616
    v_rcp_f32 v78, v78
    v_mul_f32 v77, v77, v109
    v_mul_f32 v82, s1, v82
    v_exp_f32 v81, v81
    v_mfma_f32_32x32x16_bf16 v[48:63], v[164:167], a[68:71], v[48:63]
    v_add_f32 v80, 1.0, v80
    v_rcp_f32 v79, v79
    v_mul_f32 v78, v78, v110
    v_mul_f32 v83, s1, v83
    v_exp_f32 v82, v82
    s_waitcnt lgkmcnt(8)
    v_mfma_f32_32x32x16_bf16 v[0:15], v[168:171], a[72:75], v[0:15]
    s_mul_i32 s55, s94, 0x700
    s_mul_i32 s56, s95, 0x700
    s_mul_i32 s57, s96, 0x700
    buffer_load_dwordx4 v192, s[20:23], s46 offen lds
    v_add_f32 v81, 1.0, v81
    v_rcp_f32 v80, v80
    v_mul_f32 v79, v79, v111
    v_mfma_f32_32x32x16_bf16 v[32:47], v[172:175], a[72:75], v[32:47]
    ds_read_b64_tr_b16 v[160:161], v216 offset:49152
    ds_read_b64_tr_b16 v[162:163], v216 offset:49664
    v_cvt_pk_bf16_f32 v104, v72, v73
    v_cvt_pk_bf16_f32 v105, v74, v75
    v_cvt_pk_bf16_f32 v106, v76, v77
    v_cvt_pk_bf16_f32 v107, v78, v79
    v_mul_f32 v84, s1, v84
    v_mfma_f32_32x32x16_bf16 v[16:31], v[168:171], a[76:79], v[16:31]
    ds_read_b64_tr_b16 v[164:165], v216 offset:57344
    ds_read_b64_tr_b16 v[166:167], v216 offset:57856
    v_exp_f32 v83, v83
    v_add_f32 v82, 1.0, v82
    v_rcp_f32 v81, v81
    v_mul_f32 v80, v80, v112
    v_mfma_f32_32x32x16_bf16 v[48:63], v[172:175], a[76:79], v[48:63]
    buffer_load_dwordx4 v193, s[20:23], s46 offen offset:1024 lds
    v_mul_f32 v85, s1, v85
    v_exp_f32 v84, v84
    v_add_f32 v83, 1.0, v83
    v_rcp_f32 v82, v82
    s_waitcnt lgkmcnt(8)
    v_mfma_f32_32x32x16_bf16 v[0:15], v[176:179], a[80:83], v[0:15]
    v_mul_f32 v81, v81, v113
    v_mul_f32 v86, s1, v86
    v_exp_f32 v85, v85
    v_add_f32 v84, 1.0, v84
    v_rcp_f32 v83, v83
    v_mul_f32 v82, v82, v114
    v_mfma_f32_32x32x16_bf16 v[32:47], v[180:183], a[80:83], v[32:47]
    ds_read_b64_tr_b16 v[168:169], v216 offset:51200
    ds_read_b64_tr_b16 v[170:171], v216 offset:51712
    v_mul_f32 v87, s1, v87
    v_exp_f32 v86, v86
    v_add_f32 v85, 1.0, v85
    v_rcp_f32 v84, v84
    v_mfma_f32_32x32x16_bf16 v[16:31], v[176:179], a[84:87], v[16:31]
    ds_read_b64_tr_b16 v[172:173], v216 offset:59392
    ds_read_b64_tr_b16 v[174:175], v216 offset:59904
    buffer_load_dwordx4 v194, s[20:23], s46 offen offset:2048 lds
    v_mul_f32 v83, v83, v115
    v_mul_f32 v88, s1, v88
    v_exp_f32 v87, v87
    v_add_f32 v86, 1.0, v86
    v_mfma_f32_32x32x16_bf16 v[48:63], v[180:183], a[84:87], v[48:63]
    s_waitcnt vmcnt(7)
    buffer_store_dword v204, v240, s[24:27], 0 offen offset:1024 sc1
    v_rcp_f32 v85, v85
    v_mul_f32 v84, v84, v116
    v_mul_f32 v89, s1, v89
    v_exp_f32 v88, v88
    s_waitcnt lgkmcnt(8)
    v_mfma_f32_32x32x16_bf16 v[0:15], v[184:187], a[88:91], v[0:15]
    v_add_f32 v87, 1.0, v87
    v_rcp_f32 v86, v86
    v_mul_f32 v85, v85, v117
    v_mul_f32 v90, s1, v90
    v_exp_f32 v89, v89
    v_add_f32 v88, 1.0, v88
    v_mfma_f32_32x32x16_bf16 v[32:47], v[188:191], a[88:91], v[32:47]
    ds_read_b64_tr_b16 v[176:177], v216 offset:53248
    ds_read_b64_tr_b16 v[178:179], v216 offset:53760
    buffer_load_dwordx4 v195, s[20:23], s46 offen offset:3072 lds
    s_add_u32 m0, s3, 0x4000
    v_rcp_f32 v87, v87
    v_mul_f32 v86, v86, v118
    v_mul_f32 v91, s1, v91
    v_mfma_f32_32x32x16_bf16 v[16:31], v[184:187], a[92:95], v[16:31]
    ds_read_b64_tr_b16 v[180:181], v216 offset:61440
    ds_read_b64_tr_b16 v[182:183], v216 offset:61952
    v_exp_f32 v90, v90
    v_add_f32 v89, 1.0, v89
    v_rcp_f32 v88, v88
    v_mul_f32 v87, v87, v119
    v_mfma_f32_32x32x16_bf16 v[48:63], v[188:191], a[92:95], v[48:63]
    v_cvt_pk_bf16_f32 v112, v80, v81
    v_cvt_pk_bf16_f32 v113, v82, v83
    v_cvt_pk_bf16_f32 v114, v84, v85
    v_cvt_pk_bf16_f32 v115, v86, v87
    v_mul_f32 v92, s1, v92
    v_exp_f32 v91, v91
    s_waitcnt lgkmcnt(8)
    v_mfma_f32_32x32x16_bf16 v[0:15], v[160:163], a[96:99], v[0:15]
    buffer_load_dwordx4 v192, s[20:23], s47 offen lds
    v_add_f32 v90, 1.0, v90
    v_rcp_f32 v89, v89
    v_mul_f32 v88, v88, v120
    v_mul_f32 v93, s1, v93
    v_exp_f32 v92, v92
    v_mfma_f32_32x32x16_bf16 v[32:47], v[164:167], a[96:99], v[32:47]
    ds_read_b64_tr_b16 v[184:185], v216 offset:55296
    ds_read_b64_tr_b16 v[186:187], v216 offset:55808
    v_add_f32 v91, 1.0, v91
    v_rcp_f32 v90, v90
    v_mul_f32 v89, v89, v121
    v_mul_f32 v94, s1, v94
    v_mfma_f32_32x32x16_bf16 v[16:31], v[160:163], a[100:103], v[16:31]
    ds_read_b64_tr_b16 v[188:189], v216 offset:63488
    ds_read_b64_tr_b16 v[190:191], v216 offset:64000
    v_exp_f32 v93, v93
    v_add_f32 v92, 1.0, v92
    v_rcp_f32 v91, v91
    v_mul_f32 v90, v90, v122
    v_mfma_f32_32x32x16_bf16 v[48:63], v[164:167], a[100:103], v[48:63]
    buffer_load_dwordx4 v193, s[20:23], s47 offen offset:1024 lds
    v_mul_f32 v95, s1, v95
    v_exp_f32 v94, v94
    v_add_f32 v93, 1.0, v93
    v_rcp_f32 v92, v92
    s_waitcnt lgkmcnt(8)
    v_mfma_f32_32x32x16_bf16 v[0:15], v[168:171], a[104:107], v[0:15]
    v_mul_f32 v91, v91, v123
    v_exp_f32 v95, v95
    v_add_f32 v94, 1.0, v94
    v_rcp_f32 v93, v93
    v_mul_f32 v92, v92, v124
    v_add_f32 v95, 1.0, v95
    v_mfma_f32_32x32x16_bf16 v[32:47], v[172:175], a[104:107], v[32:47]
    s_waitcnt lgkmcnt(0)
    s_barrier
    v_add_u32 v216, 0x10000, v216
    ds_read_b64_tr_b16 v[160:161], v216
    ds_read_b64_tr_b16 v[162:163], v216 offset:512
    v_accvgpr_read_b32 v250, a240
    v_accvgpr_read_b32 v251, a241
    s_add_u32 m0, s58, 0x24000
    s_nop 0
    buffer_load_dwordx4 v250, s[4:7], 0 offen lds
    buffer_load_dwordx4 v251, s[4:7], 0 offen offset:1024 lds
    s_add_u32 m0, s3, 0x4000
    v_mfma_f32_32x32x16_bf16 v[16:31], v[168:171], a[108:111], v[16:31]
    ds_read_b64_tr_b16 v[164:165], v216 offset:8192
    ds_read_b64_tr_b16 v[166:167], v216 offset:8704
    buffer_load_dwordx4 v194, s[20:23], s47 offen offset:2048 lds
    v_rcp_f32 v94, v94
    v_mul_f32 v93, v93, v125
    v_rcp_f32 v95, v95
    v_accvgpr_read_b32 v254, a242
    v_mfma_f32_32x32x16_bf16 v[48:63], v[172:175], a[108:111], v[48:63]
    v_mul_f32 v94, v94, v126
    v_mul_f32 v95, v95, v127
    v_cvt_pk_bf16_f32 v120, v88, v89
    v_cvt_pk_bf16_f32 v121, v90, v91
    v_cvt_pk_bf16_f32 v122, v92, v93
    v_cvt_pk_bf16_f32 v123, v94, v95
    s_add_u32 s101, s74, 0
    v_mfma_f32_32x32x16_bf16 v[0:15], v[176:179], a[112:115], v[0:15]
    buffer_store_dwordx4 v[96:99], v218, s[24:27], s101 offen sc1
    buffer_store_dwordx4 v[104:107], v218, s[24:27], s101 offen offset:1024 sc1
    s_add_u32 s101, s75, 0
    buffer_store_dwordx4 v[112:115], v218, s[24:27], s101 offen sc1
    buffer_store_dwordx4 v[120:123], v218, s[24:27], s101 offen offset:1024 sc1
    v_and_b32 v250, 1, v245
    v_lshlrev_b32 v250, 4, v250
    v_bfe_u32 v251, v245, 1, 4
    v_mfma_f32_32x32x16_bf16 v[32:47], v[180:183], a[112:115], v[32:47]
    ds_read_b64_tr_b16 v[168:169], v216 offset:2048
    ds_read_b64_tr_b16 v[170:171], v216 offset:2560
    buffer_load_dwordx4 v195, s[20:23], s47 offen offset:3072 lds
    s_add_u32 m0, s3, 0x8000
    v_lshrrev_b32 v252, 5, v245
    v_lshlrev_b32 v252, 2, v252
    v_sub_u32 v251, v251, v252
    v_lshlrev_b32 v254, v250, v254
    v_mfma_f32_32x32x16_bf16 v[16:31], v[176:179], a[116:119], v[16:31]
    ds_read_b64_tr_b16 v[172:173], v216 offset:10240
    ds_read_b64_tr_b16 v[174:175], v216 offset:10752
    v_cmp_eq_u32 s[82:83], v251, 0
    v_cmp_eq_u32 s[84:85], v251, 1
    v_cmp_eq_u32 s[86:87], v251, 2
    v_cmp_eq_u32 s[88:89], v251, 3
    v_cndmask_b32 v152, 0, v254, s[82:83]
    v_cndmask_b32 v153, 0, v254, s[84:85]
    v_mfma_f32_32x32x16_bf16 v[48:63], v[180:183], a[116:119], v[48:63]
    v_cndmask_b32 v154, 0, v254, s[86:87]
    v_cndmask_b32 v155, 0, v254, s[88:89]
    v_cmp_eq_u32 s[82:83], v251, 8
    v_cmp_eq_u32 s[84:85], v251, 9
    v_cmp_eq_u32 s[86:87], v251, 10
    v_cmp_eq_u32 s[88:89], v251, 11
    v_cndmask_b32 v156, 0, v254, s[82:83]
    v_mfma_f32_32x32x16_bf16 v[0:15], v[184:187], a[120:123], v[0:15]
    buffer_load_dwordx4 v192, s[20:23], s48 offen lds
    v_cndmask_b32 v157, 0, v254, s[84:85]
    v_cndmask_b32 v158, 0, v254, s[86:87]
    v_cndmask_b32 v159, 0, v254, s[88:89]
    v_mfma_f32_32x32x16_bf16 v[32:47], v[188:191], a[120:123], v[32:47]
    ds_read_b64_tr_b16 v[176:177], v216 offset:4096
    ds_read_b64_tr_b16 v[178:179], v216 offset:4608
    v_mfma_f32_32x32x16_bf16 v[16:31], v[184:187], a[124:127], v[16:31]
    ds_read_b64_tr_b16 v[180:181], v216 offset:12288
    ds_read_b64_tr_b16 v[182:183], v216 offset:12800
    v_mfma_f32_32x32x16_bf16 v[48:63], v[188:191], a[124:127], v[48:63]
    buffer_load_dwordx4 v193, s[20:23], s48 offen offset:1024 lds
    s_waitcnt lgkmcnt(8)
    v_mfma_f32_32x32x16_bf16 v[0:15], v[160:163], a[128:131], v[0:15]
    v_mfma_f32_32x32x16_bf16 v[32:47], v[164:167], a[128:131], v[32:47]
    ds_read_b64_tr_b16 v[184:185], v216 offset:6144
    ds_read_b64_tr_b16 v[186:187], v216 offset:6656
    v_mfma_f32_32x32x16_bf16 v[16:31], v[160:163], a[132:135], v[16:31]
    ds_read_b64_tr_b16 v[188:189], v216 offset:14336
    ds_read_b64_tr_b16 v[190:191], v216 offset:14848
    buffer_load_dwordx4 v194, s[20:23], s48 offen offset:2048 lds
    v_mfma_f32_32x32x16_bf16 v[48:63], v[164:167], a[132:135], v[48:63]
    s_waitcnt lgkmcnt(8)
    v_mfma_f32_32x32x16_bf16 v[0:15], v[168:171], a[136:139], v[0:15]
    v_mfma_f32_32x32x16_bf16 v[32:47], v[172:175], a[136:139], v[32:47]
    ds_read_b64_tr_b16 v[160:161], v216 offset:16384
    ds_read_b64_tr_b16 v[162:163], v216 offset:16896
    buffer_load_dwordx4 v195, s[20:23], s48 offen offset:3072 lds
    s_add_u32 m0, s3, 0xc000
    v_mfma_f32_32x32x16_bf16 v[16:31], v[168:171], a[140:143], v[16:31]
    ds_read_b64_tr_b16 v[164:165], v216 offset:24576
    ds_read_b64_tr_b16 v[166:167], v216 offset:25088
    v_mfma_f32_32x32x16_bf16 v[48:63], v[172:175], a[140:143], v[48:63]
    s_waitcnt lgkmcnt(8)
    v_mfma_f32_32x32x16_bf16 v[0:15], v[176:179], a[144:147], v[0:15]
    buffer_load_dwordx4 v192, s[20:23], s49 offen lds
    s_waitcnt vmcnt(6)
    buffer_store_dword v204, v240, s[24:27], 0 offen sc1
    v_mfma_f32_32x32x16_bf16 v[32:47], v[180:183], a[144:147], v[32:47]
    ds_read_b64_tr_b16 v[168:169], v216 offset:18432
    ds_read_b64_tr_b16 v[170:171], v216 offset:18944
    v_mfma_f32_32x32x16_bf16 v[16:31], v[176:179], a[148:151], v[16:31]
    ds_read_b64_tr_b16 v[172:173], v216 offset:26624
    ds_read_b64_tr_b16 v[174:175], v216 offset:27136
    v_mfma_f32_32x32x16_bf16 v[48:63], v[180:183], a[148:151], v[48:63]
    buffer_load_dwordx4 v193, s[20:23], s49 offen offset:1024 lds
    s_waitcnt lgkmcnt(8)
    v_mfma_f32_32x32x16_bf16 v[0:15], v[184:187], a[152:155], v[0:15]
    v_mfma_f32_32x32x16_bf16 v[32:47], v[188:191], a[152:155], v[32:47]
    ds_read_b64_tr_b16 v[176:177], v216 offset:20480
    ds_read_b64_tr_b16 v[178:179], v216 offset:20992
    v_mfma_f32_32x32x16_bf16 v[16:31], v[184:187], a[156:159], v[16:31]
    ds_read_b64_tr_b16 v[180:181], v216 offset:28672
    ds_read_b64_tr_b16 v[182:183], v216 offset:29184
    buffer_load_dwordx4 v194, s[20:23], s49 offen offset:2048 lds
    v_mfma_f32_32x32x16_bf16 v[48:63], v[188:191], a[156:159], v[48:63]
    s_waitcnt lgkmcnt(8)
    v_mfma_f32_32x32x16_bf16 v[0:15], v[160:163], a[160:163], v[0:15]
    v_mfma_f32_32x32x16_bf16 v[32:47], v[164:167], a[160:163], v[32:47]
    ds_read_b64_tr_b16 v[184:185], v216 offset:22528
    ds_read_b64_tr_b16 v[186:187], v216 offset:23040
    buffer_load_dwordx4 v195, s[20:23], s49 offen offset:3072 lds
    s_add_u32 m0, s3, 0x10000
    v_mfma_f32_32x32x16_bf16 v[16:31], v[160:163], a[164:167], v[16:31]
    ds_read_b64_tr_b16 v[188:189], v216 offset:30720
    ds_read_b64_tr_b16 v[190:191], v216 offset:31232
    v_mfma_f32_32x32x16_bf16 v[48:63], v[164:167], a[164:167], v[48:63]
    s_waitcnt lgkmcnt(8)
    v_mfma_f32_32x32x16_bf16 v[0:15], v[168:171], a[168:171], v[0:15]
    v_mfma_f32_32x32x16_bf16 v[32:47], v[172:175], a[168:171], v[32:47]
    s_waitcnt lgkmcnt(0)
    s_barrier
    ds_read_b64_tr_b16 v[160:161], v216 offset:32768
    ds_read_b64_tr_b16 v[162:163], v216 offset:33280
    buffer_load_dwordx4 v192, s[20:23], s50 offen lds
    v_mfma_f32_32x32x16_bf16 v[16:31], v[168:171], a[172:175], v[16:31]
    ds_read_b64_tr_b16 v[164:165], v216 offset:40960
    ds_read_b64_tr_b16 v[166:167], v216 offset:41472
    s_lshl_b32 s81, s99, 7
    buffer_load_dword v205, v241, s[24:27], s81 offen offset:1024 sc1
    v_mfma_f32_32x32x16_bf16 v[48:63], v[172:175], a[172:175], v[48:63]
    v_mfma_f32_32x32x16_bf16 v[0:15], v[176:179], a[176:179], v[0:15]
    buffer_load_dwordx4 v193, s[20:23], s50 offen offset:1024 lds
    v_mfma_f32_32x32x16_bf16 v[32:47], v[180:183], a[176:179], v[32:47]
    ds_read_b64_tr_b16 v[168:169], v216 offset:34816
    ds_read_b64_tr_b16 v[170:171], v216 offset:35328
    v_mfma_f32_32x32x16_bf16 v[16:31], v[176:179], a[180:183], v[16:31]
    ds_read_b64_tr_b16 v[172:173], v216 offset:43008
    ds_read_b64_tr_b16 v[174:175], v216 offset:43520
    v_mfma_f32_32x32x16_bf16 v[48:63], v[180:183], a[180:183], v[48:63]
    buffer_load_dwordx4 v194, s[20:23], s50 offen offset:2048 lds
    v_mfma_f32_32x32x16_bf16 v[0:15], v[184:187], a[184:187], v[0:15]
    v_mfma_f32_32x32x16_bf16 v[32:47], v[188:191], a[184:187], v[32:47]
    ds_read_b64_tr_b16 v[176:177], v216 offset:36864
    ds_read_b64_tr_b16 v[178:179], v216 offset:37376
    v_mfma_f32_32x32x16_bf16 v[16:31], v[184:187], a[188:191], v[16:31]
    ds_read_b64_tr_b16 v[180:181], v216 offset:45056
    ds_read_b64_tr_b16 v[182:183], v216 offset:45568
    buffer_load_dwordx4 v195, s[20:23], s50 offen offset:3072 lds
    s_add_u32 m0, s3, 0x14000
    v_mfma_f32_32x32x16_bf16 v[48:63], v[188:191], a[188:191], v[48:63]
    s_waitcnt lgkmcnt(8)
    v_mfma_f32_32x32x16_bf16 v[0:15], v[160:163], a[192:195], v[0:15]
    v_mfma_f32_32x32x16_bf16 v[32:47], v[164:167], a[192:195], v[32:47]
    ds_read_b64_tr_b16 v[184:185], v216 offset:38912
    ds_read_b64_tr_b16 v[186:187], v216 offset:39424
    buffer_load_dwordx4 v200, s[16:19], s51 offen lds
    v_mfma_f32_32x32x16_bf16 v[16:31], v[160:163], a[196:199], v[16:31]
    ds_read_b64_tr_b16 v[188:189], v216 offset:47104
    ds_read_b64_tr_b16 v[190:191], v216 offset:47616
    s_waitcnt vmcnt(4)
    v_cmp_ne_u32 vcc, 1, v205
    s_nop 0
    s_cmp_lg_u64 vcc, 0
    s_cbranch_scc1 L_slow_f2
L_ret_f2:
    buffer_load_dwordx4 a[224:227], v219, s[24:27], s64 offen sc1
    v_mfma_f32_32x32x16_bf16 v[48:63], v[164:167], a[196:199], v[48:63]
    s_waitcnt lgkmcnt(8)
    v_mfma_f32_32x32x16_bf16 v[0:15], v[168:171], a[200:203], v[0:15]
    buffer_load_dwordx4 v201, s[16:19], s51 offen offset:1024 lds
    v_mfma_f32_32x32x16_bf16 v[32:47], v[172:175], a[200:203], v[32:47]
    buffer_load_dwordx4 a[228:231], v219, s[24:27], s64 offen offset:1024 sc1
    v_mfma_f32_32x32x16_bf16 v[16:31], v[168:171], a[204:207], v[16:31]
    v_mfma_f32_32x32x16_bf16 v[48:63], v[172:175], a[204:207], v[48:63]
    buffer_load_dwordx4 v202, s[16:19], s51 offen offset:2048 lds
    s_waitcnt lgkmcnt(4)
    v_mfma_f32_32x32x16_bf16 v[0:15], v[176:179], a[208:211], v[0:15]
    buffer_load_dwordx4 a[232:235], v219, s[24:27], s65 offen sc1
    v_mfma_f32_32x32x16_bf16 v[32:47], v[180:183], a[208:211], v[32:47]
    s_waitcnt vmcnt(6) lgkmcnt(0)
    s_barrier
    s_lshl_b32 s73, s98, 6
    v_xor_b32 v208, s73, v208
    s_lshl_b32 s72, s99, 12
    s_add_u32 s72, s72, 0x1c000
    s_lshl_b32 s73, s98, 12
    v_add_u32 v222, s72, v208
    v_add_u32 v208, s73, v208
    v_xor_b32 v223, 32, v222
    v_xor_b32 v212, 0x1000, v208
    v_xor_b32 v209, 32, v208
    v_xor_b32 v213, 0x1020, v208
    v_add_u32 v208, 0xc000, v208
    ds_read_b128 v[160:163], v208 offset:32768
    v_add_u32 v212, 0xc000, v212
    ds_read_b128 v[164:167], v212 offset:32768
    v_mfma_f32_32x32x16_bf16 v[16:31], v[176:179], a[212:215], v[16:31]
    buffer_load_dwordx4 v203, s[16:19], s51 offen offset:3072 lds
    s_add_u32 m0, s3, 0x1c000
    v_mfma_f32_32x32x16_bf16 v[48:63], v[180:183], a[212:215], v[48:63]
    v_add_u32 v209, 0xc000, v209
    ds_read_b128 v[168:171], v209 offset:32768
    v_add_u32 v213, 0xc000, v213
    ds_read_b128 v[172:175], v213 offset:32768
    buffer_load_dwordx4 a[236:239], v219, s[24:27], s65 offen offset:1024 sc1
    v_mfma_f32_32x32x16_bf16 v[0:15], v[184:187], a[216:219], v[0:15]
    v_mfma_f32_32x32x16_bf16 v[32:47], v[188:191], a[216:219], v[32:47]
    ds_read_b128 v[176:179], v208 offset:49152
    ds_read_b128 v[180:183], v212 offset:49152
    buffer_load_dwordx4 a[240:243], v219, s[24:27], s66 offen sc1
    v_mfma_f32_32x32x16_bf16 v[16:31], v[184:187], a[220:223], v[16:31]
    v_mfma_f32_32x32x16_bf16 v[48:63], v[188:191], a[220:223], v[48:63]
    ds_read_b128 v[184:187], v209 offset:49152
    ds_read_b128 v[188:191], v213 offset:49152
    buffer_load_dwordx4 a[244:247], v219, s[24:27], s66 offen offset:1024 sc1
    s_lshl_b32 s81, s61, 7
    buffer_load_dword v205, v241, s[24:27], s81 offen sc1
    s_waitcnt vmcnt(9) lgkmcnt(6)
    v_mfma_f32_32x32x16_bf16 v[96:111], v[160:163], a[224:227], 0
    buffer_load_dwordx4 a[248:251], v219, s[24:27], s67 offen sc1
    v_mfma_f32_32x32x16_bf16 v[112:127], v[164:167], a[224:227], 0
    v_add_u32 v208, 0xfffec000, v208
    ds_read_b128 v[160:163], v208
    v_add_u32 v212, 0xfffec000, v212
    ds_read_b128 v[164:167], v212
    buffer_load_dwordx4 a[252:255], v219, s[24:27], s67 offen offset:1024 sc1
    v_mul_f32 v0, s1, v0
    v_mul_f32 v1, s1, v1
    v_exp_f32 v0, v0
    v_mul_f32 v2, s1, v2
    s_waitcnt vmcnt(9) lgkmcnt(6)
    v_mfma_f32_32x32x16_bf16 v[96:111], v[168:171], a[228:231], v[96:111]
    buffer_load_dwordx4 a[0:3], v219, s[24:27], s68 offen sc1
    v_exp_f32 v1, v1
    v_add_f32 v0, 1.0, v0
    v_mul_f32 v3, s1, v3
    v_exp_f32 v2, v2
    v_add_f32 v1, 1.0, v1
    v_rcp_f32 v0, v0
    v_mul_f32 v4, s1, v4
    v_mfma_f32_32x32x16_bf16 v[112:127], v[172:175], a[228:231], v[112:127]
    v_add_u32 v209, 0xfffec000, v209
    ds_read_b128 v[168:171], v209
    v_add_u32 v213, 0xfffec000, v213
    ds_read_b128 v[172:175], v213
    buffer_load_dwordx4 a[4:7], v219, s[24:27], s68 offen offset:1024 sc1
    v_exp_f32 v3, v3
    v_add_f32 v2, 1.0, v2
    v_rcp_f32 v1, v1
    v_mul_f32 v0, v0, v32
    s_waitcnt vmcnt(9) lgkmcnt(6)
    v_mfma_f32_32x32x16_bf16 v[96:111], v[176:179], a[232:235], v[96:111]
    buffer_load_dwordx4 a[8:11], v219, s[24:27], s69 offen sc1
    v_mul_f32 v5, s1, v5
    v_exp_f32 v4, v4
    v_add_f32 v3, 1.0, v3
    v_rcp_f32 v2, v2
    v_mul_f32 v1, v1, v33
    v_mul_f32 v6, s1, v6
    v_exp_f32 v5, v5
    v_add_f32 v4, 1.0, v4
    v_mfma_f32_32x32x16_bf16 v[112:127], v[180:183], a[232:235], v[112:127]
    ds_read_b128 v[176:179], v208 offset:16384
    ds_read_b128 v[180:183], v212 offset:16384
    buffer_load_dwordx4 a[12:15], v219, s[24:27], s69 offen offset:1024 sc1
    v_rcp_f32 v3, v3
    v_mul_f32 v2, v2, v34
    v_mul_f32 v7, s1, v7
    v_exp_f32 v6, v6
    v_add_f32 v5, 1.0, v5
    s_waitcnt vmcnt(9) lgkmcnt(6)
    v_mfma_f32_32x32x16_bf16 v[96:111], v[184:187], a[236:239], v[96:111]
    buffer_load_dwordx4 a[16:19], v219, s[24:27], s70 offen sc1
    v_rcp_f32 v4, v4
    v_mul_f32 v3, v3, v35
    v_mul_f32 v8, s1, v8
    v_exp_f32 v7, v7
    v_add_f32 v6, 1.0, v6
    v_rcp_f32 v5, v5
    v_mul_f32 v4, v4, v36
    v_mul_f32 v9, s1, v9
    v_mfma_f32_32x32x16_bf16 v[112:127], v[188:191], a[236:239], v[112:127]
    ds_read_b128 v[184:187], v209 offset:16384
    ds_read_b128 v[188:191], v213 offset:16384
    buffer_load_dwordx4 a[20:23], v219, s[24:27], s70 offen offset:1024 sc1
    v_exp_f32 v8, v8
    v_add_f32 v7, 1.0, v7
    v_rcp_f32 v6, v6
    v_mul_f32 v5, v5, v37
    v_mul_f32 v10, s1, v10
    s_waitcnt vmcnt(10) lgkmcnt(6)
    v_mfma_f32_32x32x16_bf16 v[96:111], v[160:163], a[240:243], v[96:111]
    v_exp_f32 v9, v9
    v_add_f32 v8, 1.0, v8
    v_rcp_f32 v7, v7
    v_mul_f32 v6, v6, v38
    v_mul_f32 v11, s1, v11
    v_exp_f32 v10, v10
    v_add_f32 v9, 1.0, v9
    v_rcp_f32 v8, v8
    v_mfma_f32_32x32x16_bf16 v[112:127], v[164:167], a[240:243], v[112:127]
    ds_read_b128 v[160:163], v208 offset:32768
    ds_read_b128 v[164:167], v212 offset:32768
    v_mul_f32 v7, v7, v39
    v_cvt_pk_bf16_f32 v32, v0, v1
    v_cvt_pk_bf16_f32 v33, v2, v3
    v_cvt_pk_bf16_f32 v34, v4, v5
    v_cvt_pk_bf16_f32 v35, v6, v7
    s_add_u32 s101, s74, 0x38000
    buffer_store_dwordx4 v[32:35], v218, s[24:27], s101 offen sc1
    v_mul_f32 v12, s1, v12
    s_waitcnt vmcnt(10) lgkmcnt(6)
    v_mfma_f32_32x32x16_bf16 v[96:111], v[168:171], a[244:247], v[96:111]
    v_exp_f32 v11, v11
    v_add_f32 v10, 1.0, v10
    v_rcp_f32 v9, v9
    v_mul_f32 v8, v8, v40
    v_mul_f32 v13, s1, v13
    v_exp_f32 v12, v12
    v_add_f32 v11, 1.0, v11
    v_rcp_f32 v10, v10
    v_mfma_f32_32x32x16_bf16 v[112:127], v[172:175], a[244:247], v[112:127]
    ds_read_b128 v[168:171], v209 offset:32768
    ds_read_b128 v[172:175], v213 offset:32768
    s_waitcnt vmcnt(9)
    v_cmp_ne_u32 vcc, 1, v205
    s_nop 0
    s_cmp_lg_u64 vcc, 0
    s_cbranch_scc1 L_slow_f0
L_ret_f0:
    v_add_u32 v206, 0xfff90000, v219
    buffer_load_dwordx4 a[24:27], v206, s[24:27], s64 offen sc1
    v_mul_f32 v9, v9, v41
    v_mul_f32 v14, s1, v14
    v_exp_f32 v13, v13
    s_waitcnt vmcnt(9) lgkmcnt(6)
    v_mfma_f32_32x32x16_bf16 v[96:111], v[176:179], a[248:251], v[96:111]
    buffer_load_dwordx4 a[28:31], v206, s[24:27], s64 offen offset:1024 sc1
    v_add_f32 v12, 1.0, v12
    v_rcp_f32 v11, v11
    v_mul_f32 v10, v10, v42
    v_mul_f32 v15, s1, v15
    v_exp_f32 v14, v14
    v_add_f32 v13, 1.0, v13
    v_rcp_f32 v12, v12
    v_mul_f32 v11, v11, v43
    v_mfma_f32_32x32x16_bf16 v[112:127], v[180:183], a[248:251], v[112:127]
    ds_read_b128 v[176:179], v208 offset:49152
    ds_read_b128 v[180:183], v212 offset:49152
    buffer_load_dwordx4 a[32:35], v206, s[24:27], s65 offen sc1
    v_mul_f32 v16, s1, v16
    v_exp_f32 v15, v15
    v_add_f32 v14, 1.0, v14
    v_rcp_f32 v13, v13
    v_mul_f32 v12, v12, v44
    v_mul_f32 v17, s1, v17
    s_waitcnt vmcnt(10) lgkmcnt(6)
    v_mfma_f32_32x32x16_bf16 v[96:111], v[184:187], a[252:255], v[96:111]
    buffer_load_dwordx4 a[36:39], v206, s[24:27], s65 offen offset:1024 sc1
    v_exp_f32 v16, v16
    v_add_f32 v15, 1.0, v15
    v_rcp_f32 v14, v14
    v_mul_f32 v13, v13, v45
    v_mul_f32 v18, s1, v18
    v_exp_f32 v17, v17
    v_add_f32 v16, 1.0, v16
    v_mfma_f32_32x32x16_bf16 v[112:127], v[188:191], a[252:255], v[112:127]
    ds_read_b128 v[184:187], v209 offset:49152
    ds_read_b128 v[188:191], v213 offset:49152
    buffer_load_dwordx4 a[40:43], v206, s[24:27], s66 offen sc1
    v_rcp_f32 v15, v15
    v_mul_f32 v14, v14, v46
    v_mul_f32 v19, s1, v19
    v_exp_f32 v18, v18
    v_add_f32 v17, 1.0, v17
    s_waitcnt vmcnt(11) lgkmcnt(6)
    v_mfma_f32_32x32x16_bf16 v[96:111], v[160:163], a[0:3], v[96:111]
    buffer_load_dwordx4 a[44:47], v206, s[24:27], s66 offen offset:1024 sc1
    v_rcp_f32 v16, v16
    v_mul_f32 v15, v15, v47
    v_cvt_pk_bf16_f32 v40, v8, v9
    v_cvt_pk_bf16_f32 v41, v10, v11
    v_cvt_pk_bf16_f32 v42, v12, v13
    v_cvt_pk_bf16_f32 v43, v14, v15
    buffer_store_dwordx4 v[40:43], v218, s[24:27], s101 offen offset:1024 sc1
    v_mul_f32 v20, s1, v20
    v_exp_f32 v19, v19
    v_mfma_f32_32x32x16_bf16 v[112:127], v[164:167], a[0:3], v[112:127]
    v_add_u32 v208, 0x10000, v208
    ds_read_b128 v[160:163], v208
    v_add_u32 v212, 0x10000, v212
    ds_read_b128 v[164:167], v212
    buffer_load_dwordx4 a[48:51], v206, s[24:27], s67 offen sc1
    v_add_f32 v18, 1.0, v18
    v_rcp_f32 v17, v17
    v_mul_f32 v16, v16, v48
    v_mul_f32 v21, s1, v21
    s_waitcnt vmcnt(13) lgkmcnt(6)
    v_mfma_f32_32x32x16_bf16 v[96:111], v[168:171], a[4:7], v[96:111]
    buffer_load_dwordx4 a[52:55], v206, s[24:27], s67 offen offset:1024 sc1
    v_exp_f32 v20, v20
    v_add_f32 v19, 1.0, v19
    v_rcp_f32 v18, v18
    v_mul_f32 v17, v17, v49
    v_mul_f32 v22, s1, v22
    v_exp_f32 v21, v21
    v_add_f32 v20, 1.0, v20
    v_mfma_f32_32x32x16_bf16 v[112:127], v[172:175], a[4:7], v[112:127]
    v_add_u32 v209, 0x10000, v209
    ds_read_b128 v[168:171], v209
    v_add_u32 v213, 0x10000, v213
    ds_read_b128 v[172:175], v213
    buffer_load_dwordx4 a[56:59], v206, s[24:27], s68 offen sc1
    v_rcp_f32 v19, v19
    v_mul_f32 v18, v18, v50
    v_mul_f32 v23, s1, v23
    v_exp_f32 v22, v22
    s_waitcnt vmcnt(14) lgkmcnt(6)
    v_mfma_f32_32x32x16_bf16 v[96:111], v[176:179], a[8:11], v[96:111]
    buffer_load_dwordx4 a[60:63], v206, s[24:27], s68 offen offset:1024 sc1
    v_add_f32 v21, 1.0, v21
    v_rcp_f32 v20, v20
    v_mul_f32 v19, v19, v51
    v_mul_f32 v24, s1, v24
    v_exp_f32 v23, v23
    v_add_f32 v22, 1.0, v22
    v_rcp_f32 v21, v21
    v_mul_f32 v20, v20, v52
    v_mfma_f32_32x32x16_bf16 v[112:127], v[180:183], a[8:11], v[112:127]
    v_lshrrev_b32 v217, 5, v245
    v_lshlrev_b32 v217, 9, v217
    s_lshl_b32 s72, s98, 12
    v_sub_u32 v216, v216, v217
    v_add_u32 v216, s72, v216
    v_xor_b32 v217, 64, v216
    ds_read_b64_tr_b16 v[176:177], v216 offset:57344
    ds_read_b64_tr_b16 v[178:179], v216 offset:58368
    buffer_load_dwordx4 a[64:67], v206, s[24:27], s69 offen sc1
    v_mul_f32 v25, s1, v25
    s_waitcnt vmcnt(15) lgkmcnt(6)
    v_mfma_f32_32x32x16_bf16 v[96:111], v[184:187], a[12:15], v[96:111]
    ds_read_b64_tr_b16 v[180:181], v217 offset:57344
    ds_read_b64_tr_b16 v[182:183], v217 offset:58368
    buffer_load_dwordx4 a[68:71], v206, s[24:27], s69 offen offset:1024 sc1
    v_exp_f32 v24, v24
    v_add_f32 v23, 1.0, v23
    v_rcp_f32 v22, v22
    v_mul_f32 v21, v21, v53
    v_mul_f32 v26, s1, v26
    v_exp_f32 v25, v25
    v_mfma_f32_32x32x16_bf16 v[112:127], v[188:191], a[12:15], v[112:127]
    ds_read_b64_tr_b16 v[184:185], v216 offset:59392
    ds_read_b64_tr_b16 v[186:187], v216 offset:60416
    buffer_load_dwordx4 a[72:75], v206, s[24:27], s70 offen sc1
    v_add_f32 v24, 1.0, v24
    v_rcp_f32 v23, v23
    v_mul_f32 v22, v22, v54
    v_mul_f32 v27, s1, v27
    v_exp_f32 v26, v26
    v_add_f32 v25, 1.0, v25
    s_waitcnt vmcnt(16) lgkmcnt(8)
    v_mfma_f32_32x32x16_bf16 v[96:111], v[160:163], a[16:19], v[96:111]
    ds_read_b64_tr_b16 v[188:189], v217 offset:59392
    ds_read_b64_tr_b16 v[190:191], v217 offset:60416
    buffer_load_dwordx4 a[76:79], v206, s[24:27], s70 offen offset:1024 sc1
    v_rcp_f32 v24, v24
    v_mul_f32 v23, v23, v55
    v_cvt_pk_bf16_f32 v48, v16, v17
    v_cvt_pk_bf16_f32 v49, v18, v19
    v_cvt_pk_bf16_f32 v50, v20, v21
    v_cvt_pk_bf16_f32 v51, v22, v23
    s_add_u32 s101, s75, 0x38000
    buffer_store_dwordx4 v[48:51], v218, s[24:27], s101 offen sc1
    v_mfma_f32_32x32x16_bf16 v[112:127], v[164:167], a[16:19], v[112:127]
    v_add_u32 v216, 0x4000, v216
    ds_read_b64_tr_b16 v[160:161], v216 offset:57344
    ds_read_b64_tr_b16 v[162:163], v216 offset:58368
    v_add_u32 v219, s79, v219
    buffer_load_dwordx4 a[80:83], v219, s[24:27], s64 offen sc1
    v_mul_f32 v28, s1, v28
    v_exp_f32 v27, v27
    v_add_f32 v26, 1.0, v26
    v_rcp_f32 v25, v25
    s_waitcnt vmcnt(18) lgkmcnt(10)
    v_mfma_f32_32x32x16_bf16 v[96:111], v[168:171], a[20:23], v[96:111]
    v_add_u32 v217, 0x4000, v217
    ds_read_b64_tr_b16 v[164:165], v217 offset:57344
    ds_read_b64_tr_b16 v[166:167], v217 offset:58368
    buffer_load_dwordx4 a[84:87], v219, s[24:27], s64 offen offset:1024 sc1
    v_mul_f32 v24, v24, v56
    v_mul_f32 v29, s1, v29
    v_exp_f32 v28, v28
    v_add_f32 v27, 1.0, v27
    v_rcp_f32 v26, v26
    v_mul_f32 v25, v25, v57
    v_mfma_f32_32x32x16_bf16 v[112:127], v[172:175], a[20:23], v[112:127]
    ds_read_b64_tr_b16 v[168:169], v216 offset:59392
    ds_read_b64_tr_b16 v[170:171], v216 offset:60416
    v_add_u32 v206, s79, v206
    buffer_load_dwordx4 a[88:91], v206, s[24:27], s64 offen sc1
    v_mul_f32 v30, s1, v30
    v_exp_f32 v29, v29
    v_add_f32 v28, 1.0, v28
    v_rcp_f32 v27, v27
    v_mul_f32 v26, v26, v58
    s_waitcnt vmcnt(18) lgkmcnt(10)
    v_mfma_f32_32x32x16_bf16 v[64:79], v[176:179], a[24:27], 0
    ds_read_b64_tr_b16 v[172:173], v217 offset:59392
    ds_read_b64_tr_b16 v[174:175], v217 offset:60416
    buffer_load_dwordx4 a[92:95], v206, s[24:27], s64 offen offset:1024 sc1
    v_mul_f32 v31, s1, v31
    v_exp_f32 v30, v30
    v_add_f32 v29, 1.0, v29
    v_rcp_f32 v28, v28
    v_mul_f32 v27, v27, v59
    v_exp_f32 v31, v31
    v_mfma_f32_32x32x16_bf16 v[80:95], v[180:183], a[24:27], 0
    v_add_u32 v216, 0xfffec000, v216
    ds_read_b64_tr_b16 v[176:177], v216 offset:8192
    ds_read_b64_tr_b16 v[178:179], v216 offset:9216
    buffer_load_dwordx4 a[96:99], v219, s[24:27], s65 offen sc1
    v_add_f32 v30, 1.0, v30
    v_rcp_f32 v29, v29
    v_mul_f32 v28, v28, v60
    v_add_f32 v31, 1.0, v31
    v_rcp_f32 v30, v30
    s_waitcnt vmcnt(19) lgkmcnt(10)
    v_mfma_f32_32x32x16_bf16 v[64:79], v[184:187], a[28:31], v[64:79]
    v_add_u32 v217, 0xfffec000, v217
    ds_read_b64_tr_b16 v[180:181], v217 offset:8192
    ds_read_b64_tr_b16 v[182:183], v217 offset:9216
    buffer_load_dwordx4 a[100:103], v219, s[24:27], s65 offen offset:1024 sc1
    v_mul_f32 v29, v29, v61
    v_rcp_f32 v31, v31
    v_mul_f32 v30, v30, v62
    v_mul_f32 v31, v31, v63
    v_cvt_pk_bf16_f32 v56, v24, v25
    v_cvt_pk_bf16_f32 v57, v26, v27
    v_cvt_pk_bf16_f32 v58, v28, v29
    v_mfma_f32_32x32x16_bf16 v[80:95], v[188:191], a[28:31], v[80:95]
    ds_read_b64_tr_b16 v[184:185], v216 offset:10240
    ds_read_b64_tr_b16 v[186:187], v216 offset:11264
    buffer_load_dwordx4 a[104:107], v206, s[24:27], s65 offen sc1
    v_cvt_pk_bf16_f32 v59, v30, v31
    buffer_store_dwordx4 v[56:59], v218, s[24:27], s101 offen offset:1024 sc1
    v_lshlrev_b32 v250, 4, v245
    s_add_u32 s100, s3, 0x18000
    s_xor_b32 s71, s100, 0x1000
    s_waitcnt vmcnt(21) lgkmcnt(10)
    v_mfma_f32_32x32x16_bf16 v[64:79], v[160:163], a[32:35], v[64:79]
    ds_read_b64_tr_b16 v[188:189], v217 offset:10240
    ds_read_b64_tr_b16 v[190:191], v217 offset:11264
    buffer_load_dwordx4 a[108:111], v206, s[24:27], s65 offen offset:1024 sc1
    v_add_u32 v243, s100, v250
    v_add_u32 v244, s71, v250
    s_mul_i32 s100, s59, 14
    s_add_u32 s100, s100, s60
    s_lshl_b32 s100, s100, 14
    s_add_u32 s100, s100, s3
    v_mfma_f32_32x32x16_bf16 v[80:95], v[164:167], a[32:35], v[80:95]
    ds_read_b64_tr_b16 v[160:161], v216 offset:24576
    ds_read_b64_tr_b16 v[162:163], v216 offset:25600
    buffer_load_dwordx4 a[112:115], v219, s[24:27], s66 offen sc1
    s_add_u32 s100, s100, 0xb20000
    v_add_u32 v225, s100, v250
    s_mul_i32 s71, s61, 0xfffc8000
    s_add_u32 s71, s71, 0x1c000
    v_add_u32 v224, s71, v225
    s_waitcnt vmcnt(22) lgkmcnt(10)
    v_mfma_f32_32x32x16_bf16 v[64:79], v[168:171], a[36:39], v[64:79]
    ds_read_b64_tr_b16 v[164:165], v217 offset:24576
    ds_read_b64_tr_b16 v[166:167], v217 offset:25600
    buffer_load_dwordx4 a[116:119], v219, s[24:27], s66 offen offset:1024 sc1
    v_sub_f32 v237, 1.0, v236
    v_mfma_f32_32x32x16_bf16 v[80:95], v[172:175], a[36:39], v[80:95]
    ds_read_b64_tr_b16 v[168:169], v216 offset:26624
    ds_read_b64_tr_b16 v[170:171], v216 offset:27648
    buffer_load_dwordx4 a[120:123], v206, s[24:27], s66 offen sc1
    s_waitcnt vmcnt(23) lgkmcnt(10)
    v_mfma_f32_32x32x16_bf16 v[64:79], v[176:179], a[40:43], v[64:79]
    ds_read_b64_tr_b16 v[172:173], v217 offset:26624
    ds_read_b64_tr_b16 v[174:175], v217 offset:27648
    v_mul_f32 v96, v236, v96
    v_mul_f32 v97, v236, v97
    v_mul_f32 v98, v236, v98
    v_mul_f32 v99, v236, v99
    v_mul_f32 v100, v236, v100
    v_mul_f32 v101, v236, v101
    v_mul_f32 v102, v236, v102
    v_mfma_f32_32x32x16_bf16 v[80:95], v[180:183], a[40:43], v[80:95]
    ds_read_b64_tr_b16 v[176:177], v216 offset:40960
    ds_read_b64_tr_b16 v[178:179], v216 offset:41984
    buffer_load_dwordx4 a[124:127], v206, s[24:27], s66 offen offset:1024 sc1
    v_mul_f32 v103, v236, v103
    v_mul_f32 v104, v236, v104
    v_mul_f32 v105, v236, v105
    v_mul_f32 v106, v236, v106
    v_mul_f32 v107, v236, v107
    s_waitcnt vmcnt(23) lgkmcnt(10)
    v_mfma_f32_32x32x16_bf16 v[64:79], v[184:187], a[44:47], v[64:79]
    ds_read_b64_tr_b16 v[180:181], v217 offset:40960
    ds_read_b64_tr_b16 v[182:183], v217 offset:41984
    v_mul_f32 v108, v236, v108
    v_mul_f32 v109, v236, v109
    v_mul_f32 v110, v236, v110
    v_mul_f32 v111, v236, v111
    v_mul_f32 v112, v236, v112
    v_mul_f32 v113, v236, v113
    v_mul_f32 v114, v236, v114
    v_mfma_f32_32x32x16_bf16 v[80:95], v[188:191], a[44:47], v[80:95]
    ds_read_b64_tr_b16 v[184:185], v216 offset:43008
    ds_read_b64_tr_b16 v[186:187], v216 offset:44032
    buffer_load_dwordx4 a[128:131], v219, s[24:27], s67 offen sc1
    v_mul_f32 v115, v236, v115
    v_mul_f32 v116, v236, v116
    v_mul_f32 v117, v236, v117
    v_mul_f32 v118, v236, v118
    v_mul_f32 v119, v236, v119
    s_waitcnt vmcnt(22) lgkmcnt(10)
    v_mfma_f32_32x32x16_bf16 v[64:79], v[160:163], a[48:51], v[64:79]
    ds_read_b64_tr_b16 v[188:189], v217 offset:43008
    ds_read_b64_tr_b16 v[190:191], v217 offset:44032
    v_mul_f32 v120, v236, v120
    v_mul_f32 v121, v236, v121
    v_mul_f32 v122, v236, v122
    v_mul_f32 v123, v236, v123
    v_mul_f32 v124, v236, v124
    v_mul_f32 v125, v236, v125
    v_mul_f32 v126, v236, v126
    v_mfma_f32_32x32x16_bf16 v[80:95], v[164:167], a[48:51], v[80:95]
    ds_read_b64_tr_b16 v[160:161], v216 offset:57344
    ds_read_b64_tr_b16 v[162:163], v216 offset:58368
    buffer_load_dwordx4 a[132:135], v219, s[24:27], s67 offen offset:1024 sc1
    v_mul_f32 v127, v236, v127
    s_waitcnt vmcnt(22) lgkmcnt(10)
    v_mfma_f32_32x32x16_bf16 v[64:79], v[168:171], a[52:55], v[64:79]
    ds_read_b64_tr_b16 v[164:165], v217 offset:57344
    ds_read_b64_tr_b16 v[166:167], v217 offset:58368
    v_mfma_f32_32x32x16_bf16 v[80:95], v[172:175], a[52:55], v[80:95]
    ds_read_b64_tr_b16 v[168:169], v216 offset:59392
    ds_read_b64_tr_b16 v[170:171], v216 offset:60416
    buffer_load_dwordx4 a[136:139], v206, s[24:27], s67 offen sc1
    s_waitcnt vmcnt(22) lgkmcnt(10)
    v_mfma_f32_32x32x16_bf16 v[64:79], v[176:179], a[56:59], v[64:79]
    ds_read_b64_tr_b16 v[172:173], v217 offset:59392
    ds_read_b64_tr_b16 v[174:175], v217 offset:60416
    v_mfma_f32_32x32x16_bf16 v[80:95], v[180:183], a[56:59], v[80:95]
    v_add_u32 v216, 0x10000, v216
    ds_read_b64_tr_b16 v[176:177], v216 offset:8192
    ds_read_b64_tr_b16 v[178:179], v216 offset:9216
    buffer_load_dwordx4 a[140:143], v206, s[24:27], s67 offen offset:1024 sc1
    s_waitcnt vmcnt(22) lgkmcnt(10)
    v_mfma_f32_32x32x16_bf16 v[64:79], v[184:187], a[60:63], v[64:79]
    v_add_u32 v217, 0x10000, v217
    ds_read_b64_tr_b16 v[180:181], v217 offset:8192
    ds_read_b64_tr_b16 v[182:183], v217 offset:9216
    v_mfma_f32_32x32x16_bf16 v[80:95], v[188:191], a[60:63], v[80:95]
    ds_read_b64_tr_b16 v[184:185], v216 offset:10240
    ds_read_b64_tr_b16 v[186:187], v216 offset:11264
    buffer_load_dwordx4 a[144:147], v219, s[24:27], s68 offen sc1
    s_waitcnt vmcnt(22) lgkmcnt(10)
    v_mfma_f32_32x32x16_bf16 v[64:79], v[160:163], a[64:67], v[64:79]
    ds_read_b64_tr_b16 v[188:189], v217 offset:10240
    ds_read_b64_tr_b16 v[190:191], v217 offset:11264
    v_mfma_f32_32x32x16_bf16 v[80:95], v[164:167], a[64:67], v[80:95]
    s_waitcnt lgkmcnt(0)
    s_barrier
    ds_read_b128 v[160:163], v208 offset:49152
    ds_read_b128 v[164:167], v212 offset:49152
    buffer_load_dwordx4 a[148:151], v219, s[24:27], s68 offen offset:1024 sc1
    s_waitcnt vmcnt(22)
    v_mfma_f32_32x32x16_bf16 v[64:79], v[168:171], a[68:71], v[64:79]
    v_mfma_f32_32x32x16_bf16 v[80:95], v[172:175], a[68:71], v[80:95]
    ds_read_b128 v[168:171], v209 offset:49152
    ds_read_b128 v[172:175], v213 offset:49152
    buffer_load_dwordx4 a[152:155], v206, s[24:27], s68 offen sc1
    s_waitcnt vmcnt(12)
    buffer_store_dword v204, v240, s[24:27], 0 offen offset:512 sc1
    v_mfma_f32_32x32x16_bf16 v[64:79], v[176:179], a[72:75], v[64:79]
    v_mfma_f32_32x32x16_bf16 v[80:95], v[180:183], a[72:75], v[80:95]
    ds_read_b64_tr_b16 v[176:177], v216 offset:57344
    ds_read_b64_tr_b16 v[178:179], v216 offset:58368
    buffer_load_dwordx4 a[156:159], v206, s[24:27], s68 offen offset:1024 sc1
    v_mfma_f32_32x32x16_bf16 v[64:79], v[184:187], a[76:79], v[64:79]
    ds_read_b64_tr_b16 v[180:181], v217 offset:57344
    ds_read_b64_tr_b16 v[182:183], v217 offset:58368
    v_mfma_f32_32x32x16_bf16 v[80:95], v[188:191], a[76:79], v[80:95]
    ds_read_b64_tr_b16 v[184:185], v216 offset:59392
    ds_read_b64_tr_b16 v[186:187], v216 offset:60416
    buffer_load_dwordx4 a[160:163], v219, s[24:27], s69 offen sc1
    s_waitcnt lgkmcnt(8)
    v_mfma_f32_32x32x16_bf16 v[32:47], v[160:163], a[80:83], 0
    ds_read_b64_tr_b16 v[188:189], v217 offset:59392
    ds_read_b64_tr_b16 v[190:191], v217 offset:60416
    v_mfma_f32_32x32x16_bf16 v[48:63], v[164:167], a[80:83], 0
    s_waitcnt lgkmcnt(0)
    s_barrier
    v_add_u32 v208, 0x4000, v208
    ds_read_b128 v[160:163], v208 offset:49152
    v_add_u32 v212, 0x4000, v212
    ds_read_b128 v[164:167], v212 offset:49152
    buffer_load_dwordx4 v200, s[16:19], s52 offen lds
    v_mfma_f32_32x32x16_bf16 v[32:47], v[168:171], a[84:87], v[32:47]
    buffer_load_dwordx4 a[164:167], v219, s[24:27], s69 offen offset:1024 sc1
    v_fma_f32 v80, v237, v80, v112
    v_fma_f32 v81, v237, v81, v113
    v_fma_f32 v82, v237, v82, v114
    v_fma_f32 v83, v237, v83, v115
    ds_write_b128 v243, v[80:83]
    v_fma_f32 v84, v237, v84, v116
    v_fma_f32 v85, v237, v85, v117
    v_mfma_f32_32x32x16_bf16 v[48:63], v[172:175], a[84:87], v[48:63]
    v_add_u32 v209, 0x4000, v209
    ds_read_b128 v[168:171], v209 offset:49152
    v_add_u32 v213, 0x4000, v213
    ds_read_b128 v[172:175], v213 offset:49152
    buffer_load_dwordx4 v201, s[16:19], s52 offen offset:1024 lds
    v_fma_f32 v86, v237, v86, v118
    v_fma_f32 v87, v237, v87, v119
    v_mfma_f32_32x32x16_bf16 v[0:15], v[176:179], a[88:91], 0
    buffer_load_dwordx4 a[168:171], v206, s[24:27], s69 offen sc1
    ds_write_b128 v243, v[84:87] offset:1024
    v_fma_f32 v88, v237, v88, v120
    v_fma_f32 v89, v237, v89, v121
    v_fma_f32 v90, v237, v90, v122
    v_fma_f32 v91, v237, v91, v123
    ds_write_b128 v243, v[88:91] offset:2048
    v_mfma_f32_32x32x16_bf16 v[16:31], v[180:183], a[88:91], 0
    v_add_u32 v216, 0x4000, v216
    ds_read_b64_tr_b16 v[176:177], v216 offset:57344
    ds_read_b64_tr_b16 v[178:179], v216 offset:58368
    buffer_load_dwordx4 v202, s[16:19], s52 offen offset:2048 lds
    v_fma_f32 v92, v237, v92, v124
    v_fma_f32 v93, v237, v93, v125
    v_fma_f32 v94, v237, v94, v126
    v_fma_f32 v95, v237, v95, v127
    v_mfma_f32_32x32x16_bf16 v[0:15], v[184:187], a[92:95], v[0:15]
    v_add_u32 v217, 0x4000, v217
    ds_read_b64_tr_b16 v[180:181], v217 offset:57344
    ds_read_b64_tr_b16 v[182:183], v217 offset:58368
    buffer_load_dwordx4 a[172:175], v206, s[24:27], s69 offen offset:1024 sc1
    ds_write_b128 v243, v[92:95] offset:3072
    v_fma_f32 v64, v237, v64, v96
    v_fma_f32 v65, v237, v65, v97
    v_fma_f32 v66, v237, v66, v98
    v_mfma_f32_32x32x16_bf16 v[16:31], v[188:191], a[92:95], v[16:31]
    ds_read_b64_tr_b16 v[184:185], v216 offset:59392
    ds_read_b64_tr_b16 v[186:187], v216 offset:60416
    buffer_load_dwordx4 v203, s[16:19], s52 offen offset:3072 lds
    s_add_u32 m0, s3, 0x20000
    v_fma_f32 v67, v237, v67, v99
    v_fma_f32 v68, v237, v68, v100
    v_fma_f32 v69, v237, v69, v101
    v_fma_f32 v70, v237, v70, v102
    s_waitcnt lgkmcnt(12)
    v_mfma_f32_32x32x16_bf16 v[32:47], v[160:163], a[96:99], v[32:47]
    ds_read_b64_tr_b16 v[188:189], v217 offset:59392
    ds_read_b64_tr_b16 v[190:191], v217 offset:60416
    buffer_load_dwordx4 a[176:179], v219, s[24:27], s70 offen sc1
    v_fma_f32 v71, v237, v71, v103
    v_fma_f32 v72, v237, v72, v104
    v_fma_f32 v73, v237, v73, v105
    v_fma_f32 v74, v237, v74, v106
    v_fma_f32 v75, v237, v75, v107
    v_fma_f32 v76, v237, v76, v108
    v_mfma_f32_32x32x16_bf16 v[48:63], v[164:167], a[96:99], v[48:63]
    s_waitcnt lgkmcnt(0)
    s_barrier
    v_add_u32 v208, 0xfffec000, v208
    ds_read_b128 v[160:163], v208
    v_add_u32 v212, 0xfffec000, v212
    ds_read_b128 v[164:167], v212
    buffer_load_dwordx4 v200, s[16:19], s53 offen lds
    v_fma_f32 v77, v237, v77, v109
    v_mfma_f32_32x32x16_bf16 v[32:47], v[168:171], a[100:103], v[32:47]
    buffer_load_dwordx4 a[180:183], v219, s[24:27], s70 offen offset:1024 sc1
    v_fma_f32 v78, v237, v78, v110
    v_fma_f32 v79, v237, v79, v111
    ds_read_b128 v[80:83], v244
    ds_read_b128 v[84:87], v244 offset:1024
    ds_read_b128 v[88:91], v244 offset:2048
    ds_read_b128 v[92:95], v244 offset:3072
    v_mfma_f32_32x32x16_bf16 v[48:63], v[172:175], a[100:103], v[48:63]
    v_add_u32 v209, 0xfffec000, v209
    ds_read_b128 v[168:171], v209
    v_add_u32 v213, 0xfffec000, v213
    ds_read_b128 v[172:175], v213
    buffer_load_dwordx4 v201, s[16:19], s53 offen offset:1024 lds
    v_mfma_f32_32x32x16_bf16 v[0:15], v[176:179], a[104:107], v[0:15]
    buffer_load_dwordx4 a[184:187], v206, s[24:27], s70 offen sc1
    v_mfma_f32_32x32x16_bf16 v[16:31], v[180:183], a[104:107], v[16:31]
    v_add_u32 v216, 0xfffec000, v216
    ds_read_b64_tr_b16 v[176:177], v216 offset:8192
    ds_read_b64_tr_b16 v[178:179], v216 offset:9216
    buffer_load_dwordx4 v202, s[16:19], s53 offen offset:2048 lds
    s_waitcnt lgkmcnt(7)
    v_add_f32 v64, v64, v80
    v_add_f32 v65, v65, v81
    v_add_f32 v66, v66, v82
    v_add_f32 v67, v67, v83
    s_waitcnt vmcnt(27)
    v_mfma_f32_32x32x16_bf16 v[0:15], v[184:187], a[108:111], v[0:15]
    v_add_u32 v217, 0xfffec000, v217
    ds_read_b64_tr_b16 v[180:181], v217 offset:8192
    ds_read_b64_tr_b16 v[182:183], v217 offset:9216
    buffer_load_dwordx4 a[188:191], v206, s[24:27], s70 offen offset:1024 sc1
    v_cvt_pk_bf16_f32 v96, v64, v65
    v_cvt_pk_bf16_f32 v97, v66, v67
    s_waitcnt lgkmcnt(8)
    v_add_f32 v68, v68, v84
    v_add_f32 v69, v69, v85
    v_add_f32 v70, v70, v86
    v_mfma_f32_32x32x16_bf16 v[16:31], v[188:191], a[108:111], v[16:31]
    ds_read_b64_tr_b16 v[184:185], v216 offset:10240
    ds_read_b64_tr_b16 v[186:187], v216 offset:11264
    buffer_load_dwordx4 v203, s[16:19], s53 offen offset:3072 lds
    s_add_u32 m0, s3, 0
    v_add_f32 v71, v71, v87
    v_cvt_pk_bf16_f32 v98, v68, v69
    v_cvt_pk_bf16_f32 v99, v70, v71
    buffer_store_dwordx4 v[96:99], v224, s[24:27], 0 offen sc1
    s_waitcnt vmcnt(29)
    v_mfma_f32_32x32x16_bf16 v[32:47], v[160:163], a[112:115], v[32:47]
    ds_read_b64_tr_b16 v[188:189], v217 offset:10240
    ds_read_b64_tr_b16 v[190:191], v217 offset:11264
    v_mfma_f32_32x32x16_bf16 v[48:63], v[164:167], a[112:115], v[48:63]
    s_waitcnt lgkmcnt(0)
    s_barrier
    ds_read_b128 v[160:163], v208 offset:16384
    ds_read_b128 v[164:167], v212 offset:16384
    buffer_load_dwordx4 v200, s[16:19], s54 offen lds
    v_add_f32 v72, v72, v88
    v_add_f32 v73, v73, v89
    v_add_f32 v74, v74, v90
    s_waitcnt vmcnt(29)
    v_mfma_f32_32x32x16_bf16 v[32:47], v[168:171], a[116:119], v[32:47]
    buffer_load_dword v205, v242, s[24:27], 0 offen offset:512 sc1
    v_add_f32 v75, v75, v91
    v_cvt_pk_bf16_f32 v100, v72, v73
    v_cvt_pk_bf16_f32 v101, v74, v75
    v_add_f32 v76, v76, v92
    v_add_f32 v77, v77, v93
    v_add_f32 v78, v78, v94
    v_add_f32 v79, v79, v95
    v_cvt_pk_bf16_f32 v102, v76, v77
    v_mfma_f32_32x32x16_bf16 v[48:63], v[172:175], a[116:119], v[48:63]
    ds_read_b128 v[168:171], v209 offset:16384
    ds_read_b128 v[172:175], v213 offset:16384
    buffer_load_dwordx4 v201, s[16:19], s54 offen offset:1024 lds
    v_cvt_pk_bf16_f32 v103, v78, v79
    buffer_store_dwordx4 v[100:103], v224, s[24:27], 0 offen offset:1024 sc1
    s_waitcnt vmcnt(31)
    v_mfma_f32_32x32x16_bf16 v[0:15], v[176:179], a[120:123], v[0:15]
    v_mfma_f32_32x32x16_bf16 v[16:31], v[180:183], a[120:123], v[16:31]
    ds_read_b64_tr_b16 v[176:177], v216 offset:24576
    ds_read_b64_tr_b16 v[178:179], v216 offset:25600
    buffer_load_dwordx4 v202, s[16:19], s54 offen offset:2048 lds
    s_lshl_b32 s100, s61, 1
    s_add_u32 s100, s100, s99
    v_and_b32 v252, 3, v245
    v_bfe_u32 v253, v245, 2, 1
    v_lshl_add_u32 v252, v253, 4, v252
    s_waitcnt vmcnt(31)
    v_mfma_f32_32x32x16_bf16 v[0:15], v[184:187], a[124:127], v[0:15]
    ds_read_b64_tr_b16 v[180:181], v217 offset:24576
    ds_read_b64_tr_b16 v[182:183], v217 offset:25600
    v_bfe_u32 v253, v245, 3, 1
    v_lshl_add_u32 v252, v253, 2, v252
    s_lshl_b32 s71, s59, 2
    s_add_u32 s100, s100, s71
    s_mul_i32 s100, s100, 0xe000
    s_lshl_b32 s71, s62, 1
    s_add_u32 s71, s71, s98
    v_mfma_f32_32x32x16_bf16 v[16:31], v[188:191], a[124:127], v[16:31]
    ds_read_b64_tr_b16 v[184:185], v216 offset:26624
    ds_read_b64_tr_b16 v[186:187], v216 offset:27648
    buffer_load_dwordx4 v203, s[16:19], s54 offen offset:3072 lds
    s_add_u32 m0, s3, 0x4000
    s_lshl_b32 s71, s71, 7
    s_add_u32 s100, s100, s71
    v_mul_u32_u24 v252, 0x700, v252
    v_bfe_u32 v253, v245, 4, 1
    s_waitcnt vmcnt(31) lgkmcnt(8)
    v_mfma_f32_32x32x16_bf16 v[32:47], v[160:163], a[128:131], v[32:47]
    ds_read_b64_tr_b16 v[188:189], v217 offset:26624
    ds_read_b64_tr_b16 v[190:191], v217 offset:27648
    v_lshl_add_u32 v252, v253, 5, v252
    v_lshrrev_b32 v253, 5, v245
    v_lshl_add_u32 v252, v253, 4, v252
    v_add_u32 v239, s100, v252
    s_mov_b32 s76, 0x3800
    s_lshl_b32 s100, s59, 4
    s_add_u32 s100, s100, s63
    v_mfma_f32_32x32x16_bf16 v[48:63], v[164:167], a[128:131], v[48:63]
    s_waitcnt lgkmcnt(0)
    s_barrier
    ds_read_b128 v[160:163], v208 offset:32768
    ds_read_b128 v[164:167], v212 offset:32768
    buffer_load_dwordx4 v200, s[16:19], s55 offen lds
    s_lshl_b32 s100, s100, 5
    s_mul_i32 s71, s61, -14
    s_add_u32 s100, s100, s71
    s_waitcnt vmcnt(31)
    v_mfma_f32_32x32x16_bf16 v[32:47], v[168:171], a[132:135], v[32:47]
    s_add_u32 s100, s100, s60
    s_lshl_b32 s100, s100, 2
    s_add_u32 s100, s100, 0xb0e61c
    v_mov_b32 v241, s100
    v_mfma_f32_32x32x16_bf16 v[48:63], v[172:175], a[132:135], v[48:63]
    ds_read_b128 v[168:171], v209 offset:32768
    ds_read_b128 v[172:175], v213 offset:32768
    buffer_load_dwordx4 v201, s[16:19], s55 offen offset:1024 lds
    s_waitcnt vmcnt(31)
    v_mfma_f32_32x32x16_bf16 v[0:15], v[176:179], a[136:139], v[0:15]
    v_mfma_f32_32x32x16_bf16 v[16:31], v[180:183], a[136:139], v[16:31]
    ds_read_b64_tr_b16 v[176:177], v216 offset:40960
    ds_read_b64_tr_b16 v[178:179], v216 offset:41984
    buffer_load_dwordx4 v202, s[16:19], s55 offen offset:2048 lds
    s_waitcnt vmcnt(31)
    v_mfma_f32_32x32x16_bf16 v[0:15], v[184:187], a[140:143], v[0:15]
    ds_read_b64_tr_b16 v[180:181], v217 offset:40960
    ds_read_b64_tr_b16 v[182:183], v217 offset:41984
    s_waitcnt vmcnt(7)
    v_cmp_ne_u32 vcc, 1, v205
    s_nop 0
    s_cmp_lg_u64 vcc, 0
    s_cbranch_scc1 L_slow_f1
L_ret_f1:
    v_add_u32 v219, s80, v206
    buffer_load_dwordx4 a[192:195], v219, s[24:27], s64 offen sc1
    v_mfma_f32_32x32x16_bf16 v[16:31], v[188:191], a[140:143], v[16:31]
    ds_read_b64_tr_b16 v[184:185], v216 offset:43008
    ds_read_b64_tr_b16 v[186:187], v216 offset:44032
    buffer_load_dwordx4 v203, s[16:19], s55 offen offset:3072 lds
    s_add_u32 m0, s3, 0x8000
    s_waitcnt lgkmcnt(8)
    v_mfma_f32_32x32x16_bf16 v[32:47], v[160:163], a[144:147], v[32:47]
    ds_read_b64_tr_b16 v[188:189], v217 offset:43008
    ds_read_b64_tr_b16 v[190:191], v217 offset:44032
    buffer_load_dwordx4 a[196:199], v219, s[24:27], s64 offen offset:1024 sc1
    v_mfma_f32_32x32x16_bf16 v[48:63], v[164:167], a[144:147], v[48:63]
    s_waitcnt lgkmcnt(0)
    s_barrier
    ds_read_b128 v[160:163], v208 offset:49152
    ds_read_b128 v[164:167], v212 offset:49152
    buffer_load_dwordx4 v200, s[16:19], s56 offen lds
    v_mfma_f32_32x32x16_bf16 v[32:47], v[168:171], a[148:151], v[32:47]
    buffer_load_dwordx4 a[200:203], v219, s[24:27], s64 offen offset:2048 sc1
    v_mfma_f32_32x32x16_bf16 v[48:63], v[172:175], a[148:151], v[48:63]
    ds_read_b128 v[168:171], v209 offset:49152
    ds_read_b128 v[172:175], v213 offset:49152
    buffer_load_dwordx4 v201, s[16:19], s56 offen offset:1024 lds
    v_mfma_f32_32x32x16_bf16 v[0:15], v[176:179], a[152:155], v[0:15]
    buffer_load_dwordx4 a[204:207], v219, s[24:27], s64 offen offset:3072 sc1
    v_mfma_f32_32x32x16_bf16 v[16:31], v[180:183], a[152:155], v[16:31]
    ds_read_b64_tr_b16 v[176:177], v216 offset:57344
    ds_read_b64_tr_b16 v[178:179], v216 offset:58368
    buffer_load_dwordx4 v202, s[16:19], s56 offen offset:2048 lds
    v_mfma_f32_32x32x16_bf16 v[0:15], v[184:187], a[156:159], v[0:15]
    ds_read_b64_tr_b16 v[180:181], v217 offset:57344
    ds_read_b64_tr_b16 v[182:183], v217 offset:58368
    buffer_load_dwordx4 a[208:211], v219, s[24:27], s65 offen sc1
    v_mfma_f32_32x32x16_bf16 v[16:31], v[188:191], a[156:159], v[16:31]
    ds_read_b64_tr_b16 v[184:185], v216 offset:59392
    ds_read_b64_tr_b16 v[186:187], v216 offset:60416
    buffer_load_dwordx4 v203, s[16:19], s56 offen offset:3072 lds
    s_add_u32 m0, s3, 0xc000
    s_waitcnt lgkmcnt(8)
    v_mfma_f32_32x32x16_bf16 v[32:47], v[160:163], a[160:163], v[32:47]
    ds_read_b64_tr_b16 v[188:189], v217 offset:59392
    ds_read_b64_tr_b16 v[190:191], v217 offset:60416
    buffer_load_dwordx4 a[212:215], v219, s[24:27], s65 offen offset:1024 sc1
    v_mfma_f32_32x32x16_bf16 v[48:63], v[164:167], a[160:163], v[48:63]
    s_waitcnt lgkmcnt(0)
    s_barrier
    v_add_u32 v208, 0x10000, v208
    ds_read_b128 v[160:163], v208
    v_add_u32 v212, 0x10000, v212
    ds_read_b128 v[164:167], v212
    buffer_load_dwordx4 v200, s[16:19], s57 offen lds
    s_waitcnt vmcnt(17)
    buffer_store_dword v204, v240, s[24:27], 0 offen offset:1536 sc1
    v_mfma_f32_32x32x16_bf16 v[32:47], v[168:171], a[164:167], v[32:47]
    buffer_load_dwordx4 a[216:219], v219, s[24:27], s65 offen offset:2048 sc1
    v_mfma_f32_32x32x16_bf16 v[48:63], v[172:175], a[164:167], v[48:63]
    v_add_u32 v209, 0x10000, v209
    ds_read_b128 v[168:171], v209
    v_add_u32 v213, 0x10000, v213
    ds_read_b128 v[172:175], v213
    buffer_load_dwordx4 v201, s[16:19], s57 offen offset:1024 lds
    v_mfma_f32_32x32x16_bf16 v[0:15], v[176:179], a[168:171], v[0:15]
    buffer_load_dwordx4 a[220:223], v219, s[24:27], s65 offen offset:3072 sc1
    v_mfma_f32_32x32x16_bf16 v[16:31], v[180:183], a[168:171], v[16:31]
    v_add_u32 v216, 0x10000, v216
    ds_read_b64_tr_b16 v[176:177], v216 offset:8192
    ds_read_b64_tr_b16 v[178:179], v216 offset:9216
    buffer_load_dwordx4 v202, s[16:19], s57 offen offset:2048 lds
    v_mfma_f32_32x32x16_bf16 v[0:15], v[184:187], a[172:175], v[0:15]
    v_add_u32 v217, 0x10000, v217
    ds_read_b64_tr_b16 v[180:181], v217 offset:8192
    ds_read_b64_tr_b16 v[182:183], v217 offset:9216
    buffer_load_dwordx4 a[224:227], v219, s[24:27], s66 offen sc1
    v_mfma_f32_32x32x16_bf16 v[16:31], v[188:191], a[172:175], v[16:31]
    ds_read_b64_tr_b16 v[184:185], v216 offset:10240
    ds_read_b64_tr_b16 v[186:187], v216 offset:11264
    buffer_load_dwordx4 v203, s[16:19], s57 offen offset:3072 lds
    s_waitcnt lgkmcnt(8)
    v_mfma_f32_32x32x16_bf16 v[32:47], v[160:163], a[176:179], v[32:47]
    ds_read_b64_tr_b16 v[188:189], v217 offset:10240
    ds_read_b64_tr_b16 v[190:191], v217 offset:11264
    buffer_load_dwordx4 a[228:231], v219, s[24:27], s66 offen offset:1024 sc1
    v_mfma_f32_32x32x16_bf16 v[48:63], v[164:167], a[176:179], v[48:63]
    ds_read_b128 v[144:147], v222
    ds_read_b128 v[148:151], v223
    buffer_load_dwordx4 a[232:235], v219, s[24:27], s66 offen offset:2048 sc1
    s_waitcnt lgkmcnt(10)
    v_mfma_f32_32x32x16_bf16 v[32:47], v[168:171], a[180:183], v[32:47]
    buffer_load_dwordx4 a[236:239], v219, s[24:27], s66 offen offset:3072 sc1
    v_mfma_f32_32x32x16_bf16 v[48:63], v[172:175], a[180:183], v[48:63]
    s_waitcnt lgkmcnt(0)
    s_barrier
    ds_read_b64_tr_b16 v[168:169], v216 offset:16384
    ds_read_b64_tr_b16 v[170:171], v216 offset:17408
    buffer_load_dwordx4 a[240:243], v219, s[24:27], s67 offen sc1
    v_mfma_f32_32x32x16_bf16 v[0:15], v[176:179], a[184:187], v[0:15]
    ds_read_b64_tr_b16 v[172:173], v217 offset:16384
    ds_read_b64_tr_b16 v[174:175], v217 offset:17408
    v_mfma_f32_32x32x16_bf16 v[16:31], v[180:183], a[184:187], v[16:31]
    ds_read_b64_tr_b16 v[176:177], v216 offset:18432
    ds_read_b64_tr_b16 v[178:179], v216 offset:19456
    buffer_load_dwordx4 a[244:247], v219, s[24:27], s67 offen offset:1024 sc1
    v_mfma_f32_32x32x16_bf16 v[0:15], v[184:187], a[188:191], v[0:15]
    ds_read_b64_tr_b16 v[180:181], v217 offset:18432
    ds_read_b64_tr_b16 v[182:183], v217 offset:19456
    buffer_load_dwordx4 a[248:251], v219, s[24:27], s67 offen offset:2048 sc1
    v_mfma_f32_32x32x16_bf16 v[16:31], v[188:191], a[188:191], v[16:31]
    ds_read_b64_tr_b16 v[184:185], v216 offset:24576
    ds_read_b64_tr_b16 v[186:187], v216 offset:25600
    v_mfma_f32_32x32x16_bf16 v[32:47], v[152:155], v[144:147], v[32:47]
    ds_read_b64_tr_b16 v[188:189], v217 offset:24576
    ds_read_b64_tr_b16 v[190:191], v217 offset:25600
    buffer_load_dwordx4 a[252:255], v219, s[24:27], s67 offen offset:3072 sc1
    v_mfma_f32_32x32x16_bf16 v[32:47], v[156:159], v[148:151], v[32:47]
    ds_read_b64_tr_b16 v[160:161], v216 offset:26624
    ds_read_b64_tr_b16 v[162:163], v216 offset:27648
    s_waitcnt vmcnt(25) lgkmcnt(10)
    v_mfma_f32_32x32x16_bf16 v[0:15], v[168:171], a[192:195], v[0:15]
    ds_read_b64_tr_b16 v[164:165], v217 offset:26624
    ds_read_b64_tr_b16 v[166:167], v217 offset:27648
    buffer_load_dwordx4 a[0:3], v219, s[24:27], s68 offen sc1
    v_mfma_f32_32x32x16_bf16 v[16:31], v[172:175], a[192:195], v[16:31]
    s_waitcnt lgkmcnt(0)
    s_barrier
    ds_read_b64_tr_b16 v[168:169], v216 offset:49152
    ds_read_b64_tr_b16 v[170:171], v216 offset:50176
    s_waitcnt vmcnt(24)
    v_mfma_f32_32x32x16_bf16 v[0:15], v[176:179], a[196:199], v[0:15]
    ds_read_b64_tr_b16 v[172:173], v217 offset:49152
    ds_read_b64_tr_b16 v[174:175], v217 offset:50176
    buffer_load_dwordx4 a[4:7], v219, s[24:27], s68 offen offset:1024 sc1
    v_mfma_f32_32x32x16_bf16 v[16:31], v[180:183], a[196:199], v[16:31]
    ds_read_b64_tr_b16 v[176:177], v216 offset:51200
    ds_read_b64_tr_b16 v[178:179], v216 offset:52224
    buffer_load_dwordx4 a[8:11], v219, s[24:27], s68 offen offset:2048 sc1
    v_mul_f32 v48, v238, v48
    v_mul_f32 v49, v238, v49
    v_mul_f32 v50, v238, v50
    v_mul_f32 v51, v238, v51
    v_mul_f32 v52, v238, v52
    s_waitcnt vmcnt(24)
    v_mfma_f32_32x32x16_bf16 v[0:15], v[184:187], a[200:203], v[0:15]
    ds_read_b64_tr_b16 v[180:181], v217 offset:51200
    ds_read_b64_tr_b16 v[182:183], v217 offset:52224
    v_mul_f32 v53, v238, v53
    v_mul_f32 v54, v238, v54
    v_mul_f32 v55, v238, v55
    v_mul_f32 v56, v238, v56
    v_mul_f32 v57, v238, v57
    v_mul_f32 v58, v238, v58
    v_mul_f32 v59, v238, v59
    v_mfma_f32_32x32x16_bf16 v[16:31], v[188:191], a[200:203], v[16:31]
    ds_read_b64_tr_b16 v[184:185], v216 offset:57344
    ds_read_b64_tr_b16 v[186:187], v216 offset:58368
    buffer_load_dwordx4 a[12:15], v219, s[24:27], s68 offen offset:3072 sc1
    v_mul_f32 v60, v238, v60
    v_mul_f32 v61, v238, v61
    v_mul_f32 v62, v238, v62
    v_mul_f32 v63, v238, v63
    v_sub_f32 v255, 1.0, v238
    s_waitcnt vmcnt(23)
    v_mfma_f32_32x32x16_bf16 v[0:15], v[160:163], a[204:207], v[0:15]
    ds_read_b64_tr_b16 v[188:189], v217 offset:57344
    ds_read_b64_tr_b16 v[190:191], v217 offset:58368
    v_mfma_f32_32x32x16_bf16 v[16:31], v[164:167], a[204:207], v[16:31]
    ds_read_b64_tr_b16 v[160:161], v216 offset:59392
    ds_read_b64_tr_b16 v[162:163], v216 offset:60416
    buffer_load_dwordx4 a[16:19], v219, s[24:27], s69 offen sc1
    s_waitcnt vmcnt(22) lgkmcnt(10)
    v_mfma_f32_32x32x16_bf16 v[0:15], v[168:171], a[208:211], v[0:15]
    ds_read_b64_tr_b16 v[164:165], v217 offset:59392
    ds_read_b64_tr_b16 v[166:167], v217 offset:60416
    buffer_load_dwordx4 a[20:23], v219, s[24:27], s69 offen offset:1024 sc1
    v_mfma_f32_32x32x16_bf16 v[16:31], v[172:175], a[208:211], v[16:31]
    s_barrier
    v_add_u32 v216, 0x4000, v216
    ds_read_b64_tr_b16 v[168:169], v216 offset:49152
    ds_read_b64_tr_b16 v[170:171], v216 offset:50176
    buffer_load_dwordx4 a[24:27], v219, s[24:27], s69 offen offset:2048 sc1
    buffer_load_dword v205, v241, s[24:27], 0 offen sc1
    s_waitcnt vmcnt(23) lgkmcnt(10)
    v_mfma_f32_32x32x16_bf16 v[0:15], v[176:179], a[212:215], v[0:15]
    v_add_u32 v217, 0x4000, v217
    ds_read_b64_tr_b16 v[172:173], v217 offset:49152
    ds_read_b64_tr_b16 v[174:175], v217 offset:50176
    buffer_load_dwordx4 a[28:31], v219, s[24:27], s69 offen offset:3072 sc1
    v_mfma_f32_32x32x16_bf16 v[16:31], v[180:183], a[212:215], v[16:31]
    ds_read_b64_tr_b16 v[176:177], v216 offset:51200
    ds_read_b64_tr_b16 v[178:179], v216 offset:52224
    buffer_load_dwordx4 a[32:35], v219, s[24:27], s70 offen sc1
    s_waitcnt vmcnt(22) lgkmcnt(10)
    v_mfma_f32_32x32x16_bf16 v[0:15], v[184:187], a[216:219], v[0:15]
    ds_read_b64_tr_b16 v[180:181], v217 offset:51200
    ds_read_b64_tr_b16 v[182:183], v217 offset:52224
    buffer_load_dwordx4 a[36:39], v219, s[24:27], s70 offen offset:1024 sc1
    v_mfma_f32_32x32x16_bf16 v[16:31], v[188:191], a[216:219], v[16:31]
    ds_read_b64_tr_b16 v[184:185], v216 offset:57344
    ds_read_b64_tr_b16 v[186:187], v216 offset:58368
    buffer_load_dwordx4 a[40:43], v219, s[24:27], s70 offen offset:2048 sc1
    s_waitcnt vmcnt(22) lgkmcnt(10)
    v_mfma_f32_32x32x16_bf16 v[0:15], v[160:163], a[220:223], v[0:15]
    ds_read_b64_tr_b16 v[188:189], v217 offset:57344
    ds_read_b64_tr_b16 v[190:191], v217 offset:58368
    buffer_load_dwordx4 a[44:47], v219, s[24:27], s70 offen offset:3072 sc1
    v_mfma_f32_32x32x16_bf16 v[16:31], v[164:167], a[220:223], v[16:31]
    ds_read_b64_tr_b16 v[160:161], v216 offset:59392
    ds_read_b64_tr_b16 v[162:163], v216 offset:60416
    s_waitcnt vmcnt(21) lgkmcnt(10)
    v_mfma_f32_32x32x16_bf16 v[0:15], v[168:171], a[224:227], v[0:15]
    ds_read_b64_tr_b16 v[164:165], v217 offset:59392
    ds_read_b64_tr_b16 v[166:167], v217 offset:60416
    v_mfma_f32_32x32x16_bf16 v[16:31], v[172:175], a[224:227], v[16:31]
    s_barrier
    v_add_u32 v216, 0xfffec000, v216
    ds_read_b64_tr_b16 v[168:169], v216
    ds_read_b64_tr_b16 v[170:171], v216 offset:1024
    s_waitcnt vmcnt(19) lgkmcnt(10)
    v_mfma_f32_32x32x16_bf16 v[0:15], v[176:179], a[228:231], v[0:15]
    v_add_u32 v217, 0xfffec000, v217
    ds_read_b64_tr_b16 v[172:173], v217
    ds_read_b64_tr_b16 v[174:175], v217 offset:1024
    v_mfma_f32_32x32x16_bf16 v[16:31], v[180:183], a[228:231], v[16:31]
    ds_read_b64_tr_b16 v[176:177], v216 offset:2048
    ds_read_b64_tr_b16 v[178:179], v216 offset:3072
    s_waitcnt vmcnt(18) lgkmcnt(10)
    v_mfma_f32_32x32x16_bf16 v[0:15], v[184:187], a[232:235], v[0:15]
    ds_read_b64_tr_b16 v[180:181], v217 offset:2048
    ds_read_b64_tr_b16 v[182:183], v217 offset:3072
    v_mfma_f32_32x32x16_bf16 v[16:31], v[188:191], a[232:235], v[16:31]
    ds_read_b64_tr_b16 v[184:185], v216 offset:8192
    ds_read_b64_tr_b16 v[186:187], v216 offset:9216
    s_waitcnt vmcnt(5)
    v_cmp_ne_u32 vcc, 1, v205
    s_nop 0
    s_cmp_lg_u64 vcc, 0
    s_cbranch_scc1 L_slow_f3
L_ret_f3:
    buffer_load_dwordx4 v[128:131], v225, s[24:27], 0 offen sc1
    s_waitcnt lgkmcnt(10)
    v_mfma_f32_32x32x16_bf16 v[0:15], v[160:163], a[236:239], v[0:15]
    ds_read_b64_tr_b16 v[188:189], v217 offset:8192
    ds_read_b64_tr_b16 v[190:191], v217 offset:9216
    v_mfma_f32_32x32x16_bf16 v[16:31], v[164:167], a[236:239], v[16:31]
    ds_read_b64_tr_b16 v[160:161], v216 offset:10240
    ds_read_b64_tr_b16 v[162:163], v216 offset:11264
    buffer_load_dwordx4 v[132:135], v225, s[24:27], 0 offen offset:1024 sc1
    s_waitcnt lgkmcnt(10)
    v_mfma_f32_32x32x16_bf16 v[0:15], v[168:171], a[240:243], v[0:15]
    ds_read_b64_tr_b16 v[164:165], v217 offset:10240
    ds_read_b64_tr_b16 v[166:167], v217 offset:11264
    v_mfma_f32_32x32x16_bf16 v[16:31], v[172:175], a[240:243], v[16:31]
    s_barrier
    ds_read_b64_tr_b16 v[168:169], v216 offset:16384
    ds_read_b64_tr_b16 v[170:171], v216 offset:17408
    s_waitcnt lgkmcnt(10)
    v_mfma_f32_32x32x16_bf16 v[0:15], v[176:179], a[244:247], v[0:15]
    ds_read_b64_tr_b16 v[172:173], v217 offset:16384
    ds_read_b64_tr_b16 v[174:175], v217 offset:17408
    v_mfma_f32_32x32x16_bf16 v[16:31], v[180:183], a[244:247], v[16:31]
    ds_read_b64_tr_b16 v[176:177], v216 offset:18432
    ds_read_b64_tr_b16 v[178:179], v216 offset:19456
    s_waitcnt lgkmcnt(10)
    v_mfma_f32_32x32x16_bf16 v[0:15], v[184:187], a[248:251], v[0:15]
    ds_read_b64_tr_b16 v[180:181], v217 offset:18432
    ds_read_b64_tr_b16 v[182:183], v217 offset:19456
    v_mfma_f32_32x32x16_bf16 v[16:31], v[188:191], a[248:251], v[16:31]
    ds_read_b64_tr_b16 v[184:185], v216 offset:24576
    ds_read_b64_tr_b16 v[186:187], v216 offset:25600
    s_waitcnt lgkmcnt(10)
    v_mfma_f32_32x32x16_bf16 v[0:15], v[160:163], a[252:255], v[0:15]
    ds_read_b64_tr_b16 v[188:189], v217 offset:24576
    ds_read_b64_tr_b16 v[190:191], v217 offset:25600
    v_mfma_f32_32x32x16_bf16 v[16:31], v[164:167], a[252:255], v[16:31]
    ds_read_b64_tr_b16 v[160:161], v216 offset:26624
    ds_read_b64_tr_b16 v[162:163], v216 offset:27648
    s_waitcnt lgkmcnt(10)
    v_mfma_f32_32x32x16_bf16 v[0:15], v[168:171], a[0:3], v[0:15]
    ds_read_b64_tr_b16 v[164:165], v217 offset:26624
    ds_read_b64_tr_b16 v[166:167], v217 offset:27648
    v_mfma_f32_32x32x16_bf16 v[16:31], v[172:175], a[0:3], v[16:31]
    ds_read_b64_tr_b16 v[172:173], v217 offset:32768
    ds_read_b64_tr_b16 v[174:175], v217 offset:33792
    ds_read_b64_tr_b16 v[92:93], v216 offset:32768
    ds_read_b64_tr_b16 v[94:95], v216 offset:33792
    s_waitcnt lgkmcnt(12)
    v_mfma_f32_32x32x16_bf16 v[0:15], v[176:179], a[4:7], v[0:15]
    v_mfma_f32_32x32x16_bf16 v[16:31], v[180:183], a[4:7], v[16:31]
    ds_read_b64_tr_b16 v[180:181], v217 offset:34816
    ds_read_b64_tr_b16 v[182:183], v217 offset:35840
    ds_read_b64_tr_b16 v[88:89], v216 offset:34816
    ds_read_b64_tr_b16 v[90:91], v216 offset:35840
    s_waitcnt lgkmcnt(12)
    v_mfma_f32_32x32x16_bf16 v[0:15], v[184:187], a[8:11], v[0:15]
    v_mfma_f32_32x32x16_bf16 v[16:31], v[188:191], a[8:11], v[16:31]
    ds_read_b64_tr_b16 v[188:189], v217 offset:40960
    ds_read_b64_tr_b16 v[190:191], v217 offset:41984
    ds_read_b64_tr_b16 v[84:85], v216 offset:40960
    ds_read_b64_tr_b16 v[86:87], v216 offset:41984
    s_waitcnt lgkmcnt(12)
    v_mfma_f32_32x32x16_bf16 v[0:15], v[160:163], a[12:15], v[0:15]
    v_mfma_f32_32x32x16_bf16 v[16:31], v[164:167], a[12:15], v[16:31]
    ds_read_b64_tr_b16 v[164:165], v217 offset:43008
    ds_read_b64_tr_b16 v[166:167], v217 offset:44032
    ds_read_b64_tr_b16 v[80:81], v216 offset:43008
    ds_read_b64_tr_b16 v[82:83], v216 offset:44032
    s_waitcnt lgkmcnt(14)
    v_mfma_f32_32x32x16_bf16 v[16:31], v[172:175], a[16:19], v[16:31]
    ds_read_b64_tr_b16 v[172:173], v217 offset:49152
    ds_read_b64_tr_b16 v[174:175], v217 offset:50176
    ds_read_b64_tr_b16 v[76:77], v216 offset:49152
    ds_read_b64_tr_b16 v[78:79], v216 offset:50176
    s_waitcnt lgkmcnt(14)
    v_mfma_f32_32x32x16_bf16 v[16:31], v[180:183], a[20:23], v[16:31]
    ds_read_b64_tr_b16 v[180:181], v217 offset:51200
    ds_read_b64_tr_b16 v[182:183], v217 offset:52224
    ds_read_b64_tr_b16 v[72:73], v216 offset:51200
    ds_read_b64_tr_b16 v[74:75], v216 offset:52224
    s_waitcnt vmcnt(1)
    v_lshlrev_b32 v246, 16, v128
    v_and_b32 v128, 0xffff0000, v128
    v_fma_f32 v32, v238, v32, v246
    v_fma_f32 v33, v238, v33, v128
    s_waitcnt lgkmcnt(14)
    v_mfma_f32_32x32x16_bf16 v[16:31], v[188:191], a[24:27], v[16:31]
    ds_read_b64_tr_b16 v[188:189], v217 offset:57344
    ds_read_b64_tr_b16 v[190:191], v217 offset:58368
    ds_read_b64_tr_b16 v[68:69], v216 offset:57344
    ds_read_b64_tr_b16 v[70:71], v216 offset:58368
    v_lshlrev_b32 v247, 16, v129
    v_and_b32 v129, 0xffff0000, v129
    v_fma_f32 v34, v238, v34, v247
    v_fma_f32 v35, v238, v35, v129
    s_waitcnt lgkmcnt(14)
    v_mfma_f32_32x32x16_bf16 v[16:31], v[164:167], a[28:31], v[16:31]
    ds_read_b64_tr_b16 v[164:165], v217 offset:59392
    ds_read_b64_tr_b16 v[166:167], v217 offset:60416
    ds_read_b64_tr_b16 v[64:65], v216 offset:59392
    ds_read_b64_tr_b16 v[66:67], v216 offset:60416
    v_lshlrev_b32 v246, 16, v130
    v_and_b32 v130, 0xffff0000, v130
    v_fma_f32 v36, v238, v36, v246
    v_fma_f32 v37, v238, v37, v130
    s_waitcnt lgkmcnt(14)
    v_mfma_f32_32x32x16_bf16 v[16:31], v[172:175], a[32:35], v[16:31]
    v_lshlrev_b32 v247, 16, v131
    v_and_b32 v131, 0xffff0000, v131
    v_fma_f32 v38, v238, v38, v247
    v_fma_f32 v39, v238, v39, v131
    s_waitcnt vmcnt(0)
    v_lshlrev_b32 v246, 16, v132
    v_and_b32 v132, 0xffff0000, v132
    v_fma_f32 v40, v238, v40, v246
    v_fma_f32 v41, v238, v41, v132
    s_waitcnt lgkmcnt(10)
    v_mfma_f32_32x32x16_bf16 v[16:31], v[180:183], a[36:39], v[16:31]
    s_waitcnt lgkmcnt(6)
    v_mfma_f32_32x32x16_bf16 v[16:31], v[188:191], a[40:43], v[16:31]
    s_waitcnt lgkmcnt(2)
    v_mfma_f32_32x32x16_bf16 v[16:31], v[164:167], a[44:47], v[16:31]
    v_lshlrev_b32 v247, 16, v133
    v_and_b32 v133, 0xffff0000, v133
    v_fma_f32 v42, v238, v42, v247
    v_fma_f32 v43, v238, v43, v133
    v_lshlrev_b32 v246, 16, v134
    v_and_b32 v134, 0xffff0000, v134
    v_fma_f32 v44, v238, v44, v246
    v_fma_f32 v45, v238, v45, v134
    v_lshlrev_b32 v247, 16, v135
    v_mfma_f32_32x32x16_bf16 v[0:15], v[92:95], a[16:19], v[0:15]
    v_and_b32 v135, 0xffff0000, v135
    v_fma_f32 v46, v238, v46, v247
    v_fma_f32 v47, v238, v47, v135
    v_fma_f32 v16, v255, v16, v48
    v_fma_f32 v17, v255, v17, v49
    v_fma_f32 v18, v255, v18, v50
    v_fma_f32 v19, v255, v19, v51
    ds_write_b128 v243, v[16:19]
    v_mfma_f32_32x32x16_bf16 v[0:15], v[88:91], a[20:23], v[0:15]
    v_fma_f32 v20, v255, v20, v52
    v_fma_f32 v21, v255, v21, v53
    v_fma_f32 v22, v255, v22, v54
    v_fma_f32 v23, v255, v23, v55
    ds_write_b128 v243, v[20:23] offset:1024
    v_fma_f32 v24, v255, v24, v56
    v_fma_f32 v25, v255, v25, v57
    v_fma_f32 v26, v255, v26, v58
    v_mfma_f32_32x32x16_bf16 v[0:15], v[84:87], a[24:27], v[0:15]
    v_fma_f32 v27, v255, v27, v59
    ds_write_b128 v243, v[24:27] offset:2048
    v_fma_f32 v28, v255, v28, v60
    v_fma_f32 v29, v255, v29, v61
    v_fma_f32 v30, v255, v30, v62
    v_fma_f32 v31, v255, v31, v63
    ds_write_b128 v243, v[28:31] offset:3072
    s_waitcnt lgkmcnt(0)
    v_mfma_f32_32x32x16_bf16 v[0:15], v[80:83], a[28:31], v[0:15]
    s_barrier
    ds_read_b128 v[16:19], v244
    ds_read_b128 v[20:23], v244 offset:1024
    ds_read_b128 v[24:27], v244 offset:2048
    ds_read_b128 v[28:31], v244 offset:3072
    v_mfma_f32_32x32x16_bf16 v[0:15], v[76:79], a[32:35], v[0:15]
    v_mfma_f32_32x32x16_bf16 v[0:15], v[72:75], a[36:39], v[0:15]
    v_mfma_f32_32x32x16_bf16 v[0:15], v[68:71], a[40:43], v[0:15]
    s_waitcnt lgkmcnt(0)
    v_add_f32 v32, v32, v16
    v_add_f32 v33, v33, v17
    v_add_f32 v34, v34, v18
    v_add_f32 v35, v35, v19
    v_add_f32 v36, v36, v20
    v_add_f32 v37, v37, v21
    v_mfma_f32_32x32x16_bf16 v[0:15], v[64:67], a[44:47], v[0:15]
    v_add_f32 v38, v38, v22
    v_add_f32 v39, v39, v23
    v_add_f32 v40, v40, v24
    v_add_f32 v41, v41, v25
    v_add_f32 v42, v42, v26
    v_add_f32 v43, v43, v27
    v_add_f32 v44, v44, v28
    v_add_f32 v45, v45, v29
    v_add_f32 v46, v46, v30
    v_add_f32 v47, v47, v31
    s_nop 1
    v_fma_f32 v0, v255, v0, v32
    v_fma_f32 v4, v255, v4, v36
    v_fma_f32 v1, v255, v1, v33
    v_fma_f32 v5, v255, v5, v37
    v_fma_f32 v2, v255, v2, v34
    v_fma_f32 v6, v255, v6, v38
    v_fma_f32 v3, v255, v3, v35
    v_fma_f32 v7, v255, v7, v39
    v_permlane16_swap_b32 v0, v4
    v_permlane16_swap_b32 v1, v5
    v_permlane16_swap_b32 v2, v6
    v_permlane16_swap_b32 v3, v7
    buffer_store_dwordx4 v[0:3], v239, s[32:35], 0 offen sc1
    buffer_store_dwordx4 v[4:7], v239, s[32:35], s76 offen sc1
    v_fma_f32 v8, v255, v8, v40
    v_fma_f32 v12, v255, v12, v44
    v_fma_f32 v9, v255, v9, v41
    v_fma_f32 v13, v255, v13, v45
    v_fma_f32 v10, v255, v10, v42
    v_fma_f32 v14, v255, v14, v46
    v_fma_f32 v11, v255, v11, v43
    v_fma_f32 v15, v255, v15, v47
    v_permlane16_swap_b32 v8, v12
    v_permlane16_swap_b32 v9, v13
    v_permlane16_swap_b32 v10, v14
    v_permlane16_swap_b32 v11, v15
    buffer_store_dwordx4 v[8:11], v239, s[32:35], 0 offen offset:64 sc1
    buffer_store_dwordx4 v[12:15], v239, s[32:35], s76 offen offset:64 sc1
L_exit:
    s_endpgm
L_slow_f2:
    s_mov_b32 s77, 0x186a0
L_spin_f2:
    s_lshl_b32 s81, s99, 7
    buffer_load_dword v205, v241, s[24:27], s81 offen offset:1024 sc1
    s_waitcnt vmcnt(0)
    v_cmp_ne_u32 vcc, 1, v205
    s_nop 1
    s_cmp_eq_u64 vcc, 0
    s_cbranch_scc1 L_ret_f2
    s_sleep 1
    s_sub_u32 s77, s77, 1
    s_cmp_lg_u32 s77, 0
    s_cbranch_scc1 L_spin_f2
    s_branch L_ret_f2
L_slow_f0:
    s_mov_b32 s77, 0x186a0
L_spin_f0:
    s_lshl_b32 s81, s61, 7
    buffer_load_dword v205, v241, s[24:27], s81 offen sc1
    s_waitcnt vmcnt(0)
    v_cmp_ne_u32 vcc, 1, v205
    s_nop 1
    s_cmp_eq_u64 vcc, 0
    s_cbranch_scc1 L_ret_f0
    s_sleep 1
    s_sub_u32 s77, s77, 1
    s_cmp_lg_u32 s77, 0
    s_cbranch_scc1 L_spin_f0
    s_branch L_ret_f0
L_slow_f1:
    s_mov_b32 s77, 0x186a0
L_spin_f1:
    buffer_load_dword v205, v242, s[24:27], 0 offen offset:512 sc1
    s_waitcnt vmcnt(0)
    v_cmp_ne_u32 vcc, 1, v205
    s_nop 1
    s_cmp_eq_u64 vcc, 0
    s_cbranch_scc1 L_ret_f1
    s_sleep 1
    s_sub_u32 s77, s77, 1
    s_cmp_lg_u32 s77, 0
    s_cbranch_scc1 L_spin_f1
    s_branch L_ret_f1
L_slow_cnt0:
    s_mov_b32 s77, 0x186a0
L_spin_cnt0:
    buffer_load_dword v205, v206, s[36:39], 0 offen sc1
    s_waitcnt vmcnt(0)
    v_cmp_ne_u32 vcc, 1, v205
    s_nop 1
    s_cmp_eq_u64 vcc, 0
    s_cbranch_scc1 L_ret_cnt0
    s_sleep 1
    s_sub_u32 s77, s77, 1
    s_cmp_lg_u32 s77, 0
    s_cbranch_scc1 L_spin_cnt0
    s_branch L_ret_cnt0
L_slow_cnt1:
    s_mov_b32 s77, 0x186a0
L_spin_cnt1:
    buffer_load_dword v205, v206, s[36:39], 0 offen offset:128 sc1
    s_waitcnt vmcnt(0)
    v_cmp_ne_u32 vcc, 1, v205
    s_nop 1
    s_cmp_eq_u64 vcc, 0
    s_cbranch_scc1 L_ret_cnt1
    s_sleep 1
    s_sub_u32 s77, s77, 1
    s_cmp_lg_u32 s77, 0
    s_cbranch_scc1 L_spin_cnt1
    s_branch L_ret_cnt1
L_slow_lb:
    s_mov_b32 s77, 0x186a0
L_spin_lb:
    s_barrier
    s_lshl_b32 s78, s63, 10
    s_add_u32 m0, s78, 0x24000
    s_nop 0
    buffer_load_dwordx4 v239, s[28:31], 0 offen sc1 lds
    s_waitcnt vmcnt(0)
    s_barrier
    ds_read_b64 v[16:17], v247
    ds_read_b64 v[18:19], v247 offset:256
    ds_read_b64 v[20:21], v247 offset:512
    ds_read_b64 v[22:23], v247 offset:768
    ds_read_b64 v[24:25], v247 offset:1024
    ds_read_b64 v[26:27], v247 offset:1280
    ds_read_b64 v[28:29], v247 offset:1536
    ds_read_b64 v[30:31], v247 offset:1792
    s_waitcnt lgkmcnt(0)
    s_waitcnt vmcnt(0)
    v_max3_u32 v246, v16, v30, v31
    v_max3_u32 v246, v246, v17, v18
    v_max3_u32 v246, v246, v19, v20
    v_max3_u32 v246, v246, v21, v22
    v_max3_u32 v246, v246, v23, v24
    v_max3_u32 v246, v246, v25, v26
    v_max3_u32 v246, v246, v27, v28
    v_max_u32 v246, v246, v29
    v_cmp_eq_u32 vcc, -1, v246
    s_nop 1
    s_cmp_eq_u64 vcc, 0
    s_cbranch_scc1 L_ret_lb
    s_sleep 1
    s_sub_u32 s77, s77, 1
    s_cmp_lg_u32 s77, 0
    s_cbranch_scc1 L_spin_lb
    s_branch L_ret_lb
L_slow_f3:
    s_mov_b32 s77, 0x186a0
L_spin_f3:
    buffer_load_dword v205, v241, s[24:27], 0 offen sc1
    s_waitcnt vmcnt(0)
    v_cmp_ne_u32 vcc, 1, v205
    s_nop 1
    s_cmp_eq_u64 vcc, 0
    s_cbranch_scc1 L_ret_f3
    s_sleep 1
    s_sub_u32 s77, s77, 1
    s_cmp_lg_u32 s77, 0
    s_cbranch_scc1 L_spin_f3
    s_branch L_ret_f3
L_spare:
    s_waitcnt lgkmcnt(0)
    s_mov_b32 s24, s96
    s_mov_b32 s25, s97
    s_mov_b32 s26, 0x10000000
    s_mov_b32 s27, 0x20000
    s_mov_b32 s36, s94
    s_mov_b32 s37, s95
    s_mov_b32 s38, 0x100
    s_mov_b32 s39, 0x20000
    s_mul_i32 s0, s2, 0xb00
    s_add_u32 s0, s0, 0xb00000
    v_lshlrev_b32 v246, 4, v0
    v_add_u32 v246, s0, v246
    v_cmp_gt_u32 vcc, 0xb0, v0
    v_mov_b32 v249, 0x7ff00000
    v_mov_b32 v4, -1
    v_mov_b32 v5, -1
    v_mov_b32 v6, -1
    v_mov_b32 v7, -1
    v_cndmask_b32 v246, v249, v246, vcc
    buffer_store_dwordx4 v[4:7], v246, s[24:27], 0 offen sc1
    s_lshr_b32 s44, s2, 3
    s_lshl_b32 s44, s44, 2
    s_add_u32 s44, s44, s63
    s_and_b32 s45, s2, 1
    s_and_b32 s46, s2, 7
    v_lshlrev_b32 v252, 4, v245
    v_lshrrev_b32 v253, 3, v245
    v_min_u32 v253, 6, v253
    v_lshlrev_b32 v253, 8, v253
    v_and_b32 v254, 7, v245
    v_lshl_add_u32 v253, v254, 4, v253
    s_getpc_b64 s[8:9]
L_pc:
    s_sub_u32 s8, s8, L_pc-gated_mix__ssm_conv_s5__glu_gated_glu__prompt_kernel
    s_subb_u32 s9, s9, 0
    s_mov_b32 s10, L_codeend-gated_mix__ssm_conv_s5__glu_gated_glu__prompt_kernel
    s_mov_b32 s11, 0x20000
    v_lshlrev_b32 v246, 7, v0
    buffer_load_dword v12, v246, s[8:11], 0 offen
    s_waitcnt vmcnt(0)
    s_barrier
    s_lshl_b32 s0, s2, 2
    v_mov_b32 v250, s0
    v_cmp_eq_u32 vcc, 0, v0
    v_mov_b32 v251, 1
    v_mov_b32 v249, 0x7ff00000
    v_cndmask_b32 v250, v249, v250, vcc
    buffer_store_dword v251, v250, s[36:39], 0 offen sc1
    s_mov_b32 s4, s64
    s_mov_b32 s5, s65
    s_mov_b32 s6, 0x1c0000
    s_mov_b32 s7, 0x20000
    s_mov_b32 s8, s90
    s_mov_b32 s9, s91
    s_mov_b32 s10, 0x380
    s_mov_b32 s11, 0x20000
    s_lshl_b32 s0, s2, 2
    s_add_u32 s0, s0, s63
    s_lshl_b32 s0, s0, 4
    v_lshrrev_b32 v247, 3, v245
    v_add_u32 v161, s0, v247
    v_and_b32 v248, 7, v245
    v_lshlrev_b32 v248, 4, v248
    v_mul_u32_u24 v246, 0x380, v161
    v_add_u32 v246, v246, v248
    s_mov_b32 s1, 0x1c00
    buffer_load_dwordx4 v[128:131], v248, s[8:11], 0 offen
    buffer_load_dwordx4 v[132:135], v248, s[8:11], 0 offen offset:128
    buffer_load_dwordx4 v[136:139], v248, s[8:11], 0 offen offset:256
    buffer_load_dwordx4 v[140:143], v248, s[8:11], 0 offen offset:384
    buffer_load_dwordx4 v[144:147], v248, s[8:11], 0 offen offset:512
    buffer_load_dwordx4 v[148:151], v248, s[8:11], 0 offen offset:640
    buffer_load_dwordx4 v[152:155], v248, s[8:11], 0 offen offset:768
    buffer_load_dwordx4 v[64:67], v246, s[4:7], 0 offen
    buffer_load_dwordx4 v[68:71], v246, s[4:7], 0 offen offset:128
    buffer_load_dwordx4 v[72:75], v246, s[4:7], 0 offen offset:256
    buffer_load_dwordx4 v[76:79], v246, s[4:7], 0 offen offset:384
    buffer_load_dwordx4 v[80:83], v246, s[4:7], 0 offen offset:512
    buffer_load_dwordx4 v[84:87], v246, s[4:7], 0 offen offset:640
    buffer_load_dwordx4 v[88:91], v246, s[4:7], 0 offen offset:768
    buffer_load_dwordx4 v[92:95], v246, s[4:7], s1 offen
    buffer_load_dwordx4 v[96:99], v246, s[4:7], s1 offen offset:128
    buffer_load_dwordx4 v[100:103], v246, s[4:7], s1 offen offset:256
    buffer_load_dwordx4 v[104:107], v246, s[4:7], s1 offen offset:384
    buffer_load_dwordx4 v[108:111], v246, s[4:7], s1 offen offset:512
    buffer_load_dwordx4 v[112:115], v246, s[4:7], s1 offen offset:640
    buffer_load_dwordx4 v[116:119], v246, s[4:7], s1 offen offset:768
    s_mov_b32 s4, s84
    s_mov_b32 s5, s85
    s_mov_b32 s6, 0x188000
    s_mov_b32 s7, 0x20000
    s_lshr_b32 s0, s2, 1
    s_mul_i32 s0, s0, 0x18800
    s_and_b32 s1, s2, 1
    s_mul_i32 s1, s1, 0x700
    s_add_u32 s0, s0, s1
    s_add_u32 s0, s0, 0
    v_lshrrev_b32 v247, 3, v0
    v_and_b32 v248, 7, v0
    v_mul_u32_u24 v246, 0xe00, v247
    v_lshl_add_u32 v246, v248, 8, v246
    v_add_u32 v246, s0, v246
    v_cmp_gt_u32 vcc, 7, v248
    v_mov_b32 v249, 0x7ff00000
    s_nop 0
    v_cndmask_b32 v246, v249, v246, vcc
    v_cmp_gt_u32 vcc, 28, v247
    s_nop 1
    v_cndmask_b32 v246, v249, v246, vcc
    buffer_load_dword v16, v246, s[4:7], 0 offen
    s_mov_b32 s4, s86
    s_mov_b32 s5, s87
    s_mov_b32 s6, 0x188000
    s_mov_b32 s7, 0x20000
    s_lshr_b32 s0, s2, 1
    s_mul_i32 s0, s0, 0x18800
    s_and_b32 s1, s2, 1
    s_mul_i32 s1, s1, 0x700
    s_add_u32 s0, s0, s1
    s_add_u32 s0, s0, 0
    v_lshrrev_b32 v247, 3, v0
    v_and_b32 v248, 7, v0
    v_mul_u32_u24 v246, 0xe00, v247
    v_lshl_add_u32 v246, v248, 8, v246
    v_add_u32 v246, s0, v246
    v_cmp_gt_u32 vcc, 7, v248
    v_mov_b32 v249, 0x7ff00000
    s_nop 0
    v_cndmask_b32 v246, v249, v246, vcc
    v_cmp_gt_u32 vcc, 28, v247
    s_nop 1
    v_cndmask_b32 v246, v249, v246, vcc
    buffer_load_dword v20, v246, s[4:7], 0 offen
    s_waitcnt vmcnt(2)
    v_mov_b32 v162, 0
    v_mov_b32 v163, 0
    v_dot2c_f32_bf16 v162, v64, v128
    v_dot2c_f32_bf16 v163, v92, v128
    v_dot2c_f32_bf16 v162, v65, v129
    v_dot2c_f32_bf16 v163, v93, v129
    v_dot2c_f32_bf16 v162, v66, v130
    v_dot2c_f32_bf16 v163, v94, v130
    v_dot2c_f32_bf16 v162, v67, v131
    v_dot2c_f32_bf16 v163, v95, v131
    v_dot2c_f32_bf16 v162, v68, v132
    v_dot2c_f32_bf16 v163, v96, v132
    v_dot2c_f32_bf16 v162, v69, v133
    v_dot2c_f32_bf16 v163, v97, v133
    v_dot2c_f32_bf16 v162, v70, v134
    v_dot2c_f32_bf16 v163, v98, v134
    v_dot2c_f32_bf16 v162, v71, v135
    v_dot2c_f32_bf16 v163, v99, v135
    v_dot2c_f32_bf16 v162, v72, v136
    v_dot2c_f32_bf16 v163, v100, v136
    v_dot2c_f32_bf16 v162, v73, v137
    v_dot2c_f32_bf16 v163, v101, v137
    v_dot2c_f32_bf16 v162, v74, v138
    v_dot2c_f32_bf16 v163, v102, v138
    v_dot2c_f32_bf16 v162, v75, v139
    v_dot2c_f32_bf16 v163, v103, v139
    v_dot2c_f32_bf16 v162, v76, v140
    v_dot2c_f32_bf16 v163, v104, v140
    v_dot2c_f32_bf16 v162, v77, v141
    v_dot2c_f32_bf16 v163, v105, v141
    v_dot2c_f32_bf16 v162, v78, v142
    v_dot2c_f32_bf16 v163, v106, v142
    v_dot2c_f32_bf16 v162, v79, v143
    v_dot2c_f32_bf16 v163, v107, v143
    v_dot2c_f32_bf16 v162, v80, v144
    v_dot2c_f32_bf16 v163, v108, v144
    v_dot2c_f32_bf16 v162, v81, v145
    v_dot2c_f32_bf16 v163, v109, v145
    v_dot2c_f32_bf16 v162, v82, v146
    v_dot2c_f32_bf16 v163, v110, v146
    v_dot2c_f32_bf16 v162, v83, v147
    v_dot2c_f32_bf16 v163, v111, v147
    v_dot2c_f32_bf16 v162, v84, v148
    v_dot2c_f32_bf16 v163, v112, v148
    v_dot2c_f32_bf16 v162, v85, v149
    v_dot2c_f32_bf16 v163, v113, v149
    v_dot2c_f32_bf16 v162, v86, v150
    v_dot2c_f32_bf16 v163, v114, v150
    v_dot2c_f32_bf16 v162, v87, v151
    v_dot2c_f32_bf16 v163, v115, v151
    v_dot2c_f32_bf16 v162, v88, v152
    v_dot2c_f32_bf16 v163, v116, v152
    v_dot2c_f32_bf16 v162, v89, v153
    v_dot2c_f32_bf16 v163, v117, v153
    v_dot2c_f32_bf16 v162, v90, v154
    v_dot2c_f32_bf16 v163, v118, v154
    v_dot2c_f32_bf16 v162, v91, v155
    v_dot2c_f32_bf16 v163, v119, v155
    s_nop 2
    v_add_f32_dpp v162, v162, v162 quad_perm:[1,0,3,2] row_mask:0xf bank_mask:0xf
    v_add_f32_dpp v163, v163, v163 quad_perm:[1,0,3,2] row_mask:0xf bank_mask:0xf
    s_nop 1
    v_add_f32_dpp v162, v162, v162 quad_perm:[2,3,0,1] row_mask:0xf bank_mask:0xf
    v_add_f32_dpp v163, v163, v163 quad_perm:[2,3,0,1] row_mask:0xf bank_mask:0xf
    s_nop 1
    v_add_f32_dpp v162, v162, v162 row_half_mirror row_mask:0xf bank_mask:0xf
    v_add_f32_dpp v163, v163, v163 row_half_mirror row_mask:0xf bank_mask:0xf
    s_nop 1
    v_mul_f32 v162, 0xbfb8aa3b, v162
    v_mul_f32 v163, 0xbfb8aa3b, v163
    v_exp_f32 v162, v162
    v_exp_f32 v163, v163
    v_add_f32 v162, 1.0, v162
    v_add_f32 v163, 1.0, v163
    v_rcp_f32 v162, v162
    v_rcp_f32 v163, v163
    v_lshlrev_b32 v161, 2, v161
    v_add_u32 v161, 0xb18000, v161
    v_and_b32 v160, 7, v245
    v_cmp_eq_u32 vcc, 0, v160
    v_mov_b32 v160, 0x7ff00000
    s_nop 0
    v_cndmask_b32 v161, v160, v161, vcc
    buffer_store_dword v162, v161, s[24:27], 0 offen sc1
    buffer_store_dword v163, v161, s[24:27], 0 offen offset:32 sc1
    s_mov_b32 s4, s84
    s_mov_b32 s5, s85
    s_mov_b32 s6, 0x188000
    s_mov_b32 s7, 0x20000
    s_lshr_b32 s0, s2, 1
    s_mul_i32 s0, s0, 0x18800
    s_and_b32 s1, s2, 1
    s_mul_i32 s1, s1, 0x700
    s_add_u32 s0, s0, s1
    s_add_u32 s0, s0, 0x80
    v_lshrrev_b32 v247, 3, v0
    v_and_b32 v248, 7, v0
    v_mul_u32_u24 v246, 0xe00, v247
    v_lshl_add_u32 v246, v248, 8, v246
    v_add_u32 v246, s0, v246
    v_cmp_gt_u32 vcc, 7, v248
    v_mov_b32 v249, 0x7ff00000
    s_nop 0
    v_cndmask_b32 v246, v249, v246, vcc
    v_cmp_gt_u32 vcc, 28, v247
    s_nop 1
    v_cndmask_b32 v246, v249, v246, vcc
    buffer_load_dword v24, v246, s[4:7], 0 offen
    s_mov_b32 s4, s86
    s_mov_b32 s5, s87
    s_mov_b32 s6, 0x188000
    s_mov_b32 s7, 0x20000
    s_lshr_b32 s0, s2, 1
    s_mul_i32 s0, s0, 0x18800
    s_and_b32 s1, s2, 1
    s_mul_i32 s1, s1, 0x700
    s_add_u32 s0, s0, s1
    s_add_u32 s0, s0, 0x80
    v_lshrrev_b32 v247, 3, v0
    v_and_b32 v248, 7, v0
    v_mul_u32_u24 v246, 0xe00, v247
    v_lshl_add_u32 v246, v248, 8, v246
    v_add_u32 v246, s0, v246
    v_cmp_gt_u32 vcc, 7, v248
    v_mov_b32 v249, 0x7ff00000
    s_nop 0
    v_cndmask_b32 v246, v249, v246, vcc
    v_cmp_gt_u32 vcc, 28, v247
    s_nop 1
    v_cndmask_b32 v246, v249, v246, vcc
    buffer_load_dword v28, v246, s[4:7], 0 offen
    s_waitcnt vmcnt(0)
    s_barrier
    s_lshl_b32 s0, s2, 2
    v_mov_b32 v250, s0
    v_cmp_eq_u32 vcc, 0, v0
    v_mov_b32 v251, 1
    v_mov_b32 v249, 0x7ff00000
    v_cndmask_b32 v250, v249, v250, vcc
    buffer_store_dword v251, v250, s[36:39], 0 offen offset:128 sc1
    s_mov_b32 s4, s74
    s_mov_b32 s5, s75
    s_mov_b32 s6, 0x62000
    s_mov_b32 s7, 0x20000
    s_mul_i32 s0, s2, 0x3100
    v_lshlrev_b32 v246, 4, v0
    v_add_u32 v246, s0, v246
    buffer_load_dwordx4 v[32:35], v246, s[4:7], 0 offen
    v_add_u32 v246, 0x1000, v246
    buffer_load_dwordx4 v[36:39], v246, s[4:7], 0 offen
    v_add_u32 v246, 0x1000, v246
    buffer_load_dwordx4 v[40:43], v246, s[4:7], 0 offen
    v_add_u32 v246, 0x1000, v246
    buffer_load_dwordx4 v[44:47], v246, s[4:7], 0 offen
    s_mov_b32 s4, s76
    s_mov_b32 s5, s77
    s_mov_b32 s6, 0x62000
    s_mov_b32 s7, 0x20000
    s_mul_i32 s0, s2, 0x3100
    v_lshlrev_b32 v246, 4, v0
    v_add_u32 v246, s0, v246
    buffer_load_dwordx4 v[48:51], v246, s[4:7], 0 offen
    v_add_u32 v246, 0x1000, v246
    buffer_load_dwordx4 v[52:55], v246, s[4:7], 0 offen
    v_add_u32 v246, 0x1000, v246
    buffer_load_dwordx4 v[8:11], v246, s[4:7], 0 offen
    v_add_u32 v246, 0x1000, v246
    buffer_load_dwordx4 v[12:15], v246, s[4:7], 0 offen
    s_mov_b32 s4, s88
    s_mov_b32 s5, s89
    s_mov_b32 s6, 0x188000
    s_mov_b32 s7, 0x20000
    s_mul_i32 s0, s2, 0xc400
    v_lshlrev_b32 v246, 4, v0
    v_add_u32 v246, s0, v246
    buffer_load_dwordx4 v[16:19], v246, s[4:7], 0 offen
    v_add_u32 v246, 0x1000, v246
    buffer_load_dwordx4 v[20:23], v246, s[4:7], 0 offen
    v_add_u32 v246, 0x1000, v246
    buffer_load_dwordx4 v[24:27], v246, s[4:7], 0 offen
    v_add_u32 v246, 0x1000, v246
    buffer_load_dwordx4 v[28:31], v246, s[4:7], 0 offen
    v_add_u32 v246, 0x1000, v246
    buffer_load_dwordx4 v[32:35], v246, s[4:7], 0 offen
    v_add_u32 v246, 0x1000, v246
    buffer_load_dwordx4 v[36:39], v246, s[4:7], 0 offen
    v_add_u32 v246, 0x1000, v246
    buffer_load_dwordx4 v[40:43], v246, s[4:7], 0 offen
    v_add_u32 v246, 0x1000, v246
    buffer_load_dwordx4 v[44:47], v246, s[4:7], 0 offen
    v_add_u32 v246, 0x1000, v246
    buffer_load_dwordx4 v[48:51], v246, s[4:7], 0 offen
    v_add_u32 v246, 0x1000, v246
    buffer_load_dwordx4 v[52:55], v246, s[4:7], 0 offen
    v_add_u32 v246, 0x1000, v246
    buffer_load_dwordx4 v[8:11], v246, s[4:7], 0 offen
    v_add_u32 v246, 0x1000, v246
    buffer_load_dwordx4 v[12:15], v246, s[4:7], 0 offen
    v_add_u32 v246, 0x1000, v246
    buffer_load_dwordx4 v[16:19], v246, s[4:7], 0 offen
    s_waitcnt vmcnt(0)
    s_endpgm
L_codeend:
.section .rodata,"a"
.p2align 6
.amdhsa_kernel gated_mix__ssm_conv_s5__glu_gated_glu__prompt_kernel
  .amdhsa_next_free_vgpr 512
  .amdhsa_next_free_sgpr 102
  .amdhsa_accum_offset 256
  .amdhsa_group_segment_fixed_size 0
  .amdhsa_kernarg_size 136
  .amdhsa_user_sgpr_count 2
  .amdhsa_user_sgpr_kernarg_segment_ptr 1
  .amdhsa_system_sgpr_workgroup_id_x 1
  .amdhsa_float_denorm_mode_32 3
.end_amdhsa_kernel
```
